```python
import torch

def _softmax(x, axis=-1):
    return torch.softmax(x, dim=axis)
def _gelu(x):
    return torch.nn.functional.gelu(x, approximate="tanh")
def _silu(x):
    return torch.nn.functional.silu(x)
def _sigmoid(x):
    return torch.sigmoid(x)
def _layernorm(x, axis=-1, eps=1e-5):
    m = x.mean(dim=axis, keepdim=True)
    v = x.var(dim=axis, keepdim=True, unbiased=False)
    return (x - m) / torch.sqrt(v + eps)
def _scatter_add(tgt, idx, src, axis=0):
    return tgt.clone().index_add_(axis, idx, src)
def _segment_sum(src, seg, n):
    out = torch.zeros((n,) + src.shape[1:], dtype=src.dtype)
    return out.index_add_(0, seg, src)
def _pad(x, pw):
    flat = tuple(v for pair in reversed(pw) for v in pair)
    return torch.nn.functional.pad(x, flat)

kernel_name = 'sequential_preLN__ssm_conv_s4__glu_gated_reglu__prompt'

def setup_inputs():

    _w = (lambda a: (lambda t: t.to(torch.bfloat16) if t.is_floating_point() else t)(torch.as_tensor(a)))
    def _A_setup():
        B, L, D, N = 1, 2048, 448, 256
        A_re = -(lambda _x: torch.exp(torch.as_tensor(_x)))((lambda *s: torch.randn(*s, dtype=torch.bfloat16) * 3.2)(D, N))
        A_im = torch.pi * (lambda *s: torch.randn(*s, dtype=torch.bfloat16) * 0.05)(D, N)
        B_re = (lambda *s: torch.randn(*s, dtype=torch.bfloat16) * 0.05)(D, N)
        B_im = (lambda *s: torch.randn(*s, dtype=torch.bfloat16) * 0.05)(D, N)
        C_re = (lambda *s: torch.randn(*s, dtype=torch.bfloat16) * 0.05)(D, N)
        C_im = (lambda *s: torch.randn(*s, dtype=torch.bfloat16) * 0.05)(D, N)
        log_dt = (lambda *s: torch.randn(*s, dtype=torch.bfloat16) * 0.05)(D) * 0.5 - 4.0
        Dskip = (lambda *s: torch.randn(*s, dtype=torch.bfloat16) * 0.05)(D)
        return {
            "u": _w((lambda *s: torch.randn(*s, dtype=torch.bfloat16) * 0.05)(B, L, D)),
            "A_re": _w(A_re),
            "A_im": _w(A_im),
            "B_re": _w(B_re),
            "B_im": _w(B_im),
            "C_re": _w(C_re),
            "C_im": _w(C_im),
            "log_dt": _w(log_dt),
            "Dskip": _w(Dskip),
        }
    _A_in = _A_setup()

    def _B_setup():
        B, S, D, F = 1, 2048, 448, 1792
        return {
            "x": _w((lambda *s: torch.randn(*s, dtype=torch.bfloat16) * 0.05)(B, S, D)),
            "W_gate": _w((lambda *s: torch.randn(*s, dtype=torch.bfloat16) * 0.4)(D, F) * (2.0 / D) ** 0.5),
            "W_up": _w((lambda *s: torch.randn(*s, dtype=torch.bfloat16) * 0.4)(D, F) * (2.0 / D) ** 0.5),
            "W_down": _w((lambda *s: torch.randn(*s, dtype=torch.bfloat16) * 0.4)(F, D) * (1.0 / F) ** 0.5),
        }
    _B_in = _B_setup()

    return {
        "A_u": _A_in["u"],
        "A_A_re": _A_in["A_re"],
        "A_A_im": _A_in["A_im"],
        "A_B_re": _A_in["B_re"],
        "A_B_im": _A_in["B_im"],
        "A_C_re": _A_in["C_re"],
        "A_C_im": _A_in["C_im"],
        "A_log_dt": _A_in["log_dt"],
        "A_Dskip": _A_in["Dskip"],
        "B_x": _B_in["x"],
        "B_W_gate": _B_in["W_gate"],
        "B_W_up": _B_in["W_up"],
        "B_W_down": _B_in["W_down"],
    }

def reference(A_u, A_A_re, A_A_im, A_B_re, A_B_im, A_C_re, A_C_im, A_log_dt, A_Dskip, B_x, B_W_gate, B_W_up, B_W_down):
    def _A_ref(u, A_re, A_im, B_re, B_im, C_re, C_im, log_dt, Dskip):
        Bsz, L, D = u.shape
        dt = torch.exp(log_dt)[:, None]
        A = A_re + 1j * A_im
        Bc = B_re + 1j * B_im
        Cc = C_re + 1j * C_im
        logdA = dt * A
        dB = dt * Bc
        l = (lambda x, dt: x.to(dt))(torch.arange(L), A_re.dtype)
        P = torch.exp(logdA[:, :, None] * l[None, None, :])
        K = torch.einsum("dn,dnl,dn->dl", Cc, P, dB).real
        L2 = 2 * L
        Kp = _pad(K, ((0, 0), (0, L)))
        up = (lambda x, *d: x.permute(*d))(u, 0, 2, 1)
        up = _pad(up, ((0, 0), (0, 0), (0, L)))
        Kf = (lambda x, axes=(-2,-1): torch.fft.rfft2(x.float(), dim=axes))(Kp[:, None, :], axes=(-2, -1))
        Uf = (lambda x, axes=(-2,-1): torch.fft.rfft2(x.float(), dim=axes))(up[:, :, None, :], axes=(-2, -1))
        Yf = Uf * Kf[None, :, :, :]
        y = (lambda x, s, axes=(-2,-1): torch.fft.irfft2(x, s=s, dim=axes).to(torch.bfloat16))(Yf, (1, L2), axes=(-2, -1))[:, :, 0, :L]
        y = (lambda x, *d: x.permute(*d))(y, 0, 2, 1) + u * Dskip[None, None, :]
        return y

    def _B_ref(x, W_gate, W_up, W_down):
        gate = torch.einsum("bsd,df->bsf", x, W_gate)
        up = torch.einsum("bsd,df->bsf", x, W_up)
        gate = gate * (lambda x, dt: x.to(dt))(gate > 0, gate.dtype)
        h = gate * up
        return torch.einsum("bsf,fd->bsd", h, W_down)

    x = A_u
    h = x + _A_ref(_layernorm(x, axis=-1), A_A_re, A_A_im, A_B_re, A_B_im, A_C_re, A_C_im, A_log_dt, A_Dskip)
    h2 = h + _B_ref(_layernorm(h, axis=-1), B_W_gate, B_W_up, B_W_down)
    return h2
```

```asm
; @launch kernel=k1_kernel grid=(256,1,1) block=(512,1,1) lds=161056
; @launch kernel=k2_kernel grid=(256,1,1) block=(512,1,1) lds=158208
.amdgcn_target "amdgcn-amd-amdhsa--gfx950"
.text
.globl k1_kernel
.p2align 8
.type k1_kernel,@function
k1_kernel:
    s_cmp_ge_u32 s2, 256
    s_cbranch_scc1 L_k1_kernel_exit
    s_load_dwordx16 s[16:31], s[0:1], 0
    s_load_dwordx16 s[32:47], s[0:1], 64
    s_getpc_b64 s[60:61]
L_k1_pc0:
    v_lshrrev_b32 v1, 6, v0
    v_and_b32 v2, 63, v0
    v_readfirstlane_b32 s48, v1
    v_min_u32 v3, 55, v2
    s_lshl_b32 s62, s2, 3
    s_add_u32 s62, s62, s48
    s_mul_i32 s63, s62, 896
    v_lshl_add_u32 v6, v3, 4, s63
    s_and_b32 s54, s2, 7
    s_lshr_b32 s55, s2, 3
    s_min_u32 s56, s55, 27
    s_mul_i32 s51, s54, 28
    s_add_u32 s51, s51, s56
    s_lshl_b32 s63, s51, 10
    v_lshl_add_u32 v4, v0, 1, s63
    v_lshlrev_b32_e64 v1, 7, v0
    v_min_u32 v1, k1_code_end-L_k1_pc0-4, v1
    s_mov_b64 s[12:13], s[60:61]
    s_add_u32 s60, s60, k1_gtab-L_k1_pc0
    s_addc_u32 s61, s61, 0
    s_lshl_b32 s63, s48, 7
    s_add_u32 s64, s60, s63
    s_addc_u32 s65, s61, 0
    s_waitcnt lgkmcnt(0)
    global_load_dwordx4 v[16:19], v6, s[16:17]
    s_load_dword s53, s[46:47], 0
    s_barrier
    s_nop 0
    global_load_dword v25, v1, s[12:13]
    global_load_ushort v8, v4, s[18:19]
    global_load_ushort v9, v4, s[20:21]
    global_load_ushort v10, v4, s[22:23]
    global_load_ushort v11, v4, s[24:25]
    global_load_ushort v12, v4, s[26:27]
    global_load_ushort v13, v4, s[28:29]
    s_lshl_b32 s63, s51, 2
    s_load_dword s57, s[30:31], s63
    s_load_dword s58, s[32:33], s63
    s_load_dwordx8 s[4:11], s[64:65], 4288
    v_and_b32 v5, 255, v0
    v_lshlrev_b32 v5, 4, v5
    global_load_dwordx4 v[20:23], v5, s[60:61]
    global_load_ushort v24, v5, s[60:61] offset:16
    s_load_dwordx16 s[76:91], s[64:65], 4224
    s_lshr_b32 s49, s48, 2
    s_mul_i32 s63, s48, 912
    s_add_u32 s63, s63, 152864
    v_lshl_add_u32 v27, v3, 4, s63
    v_and_b32 v37, 3, v2
    v_mul_u32_u24 v31, 1824, v37
    v_add_u32 v31, 152864, v31
    v_and_b32 v29, -4, v0
    v_add_u32 v28, v31, v29
    v_min_u32 v29, 384, v29
    v_add_u32 v26, v31, v29
    s_lshr_b32 s63, s2, 1
    s_mul_i32 s63, s63, 28672
    s_and_b32 s62, s2, 1
    s_lshl_b32 s62, s62, 6
    s_add_u32 s63, s63, s62
    s_add_u32 s63, s63, 16777216
    v_and_b32 v29, -4, v0
    v_lshlrev_b32_e64 v29, 5, v29
    v_lshl_add_u32 v29, v37, 4, v29
    v_add_u32 v29, s63, v29
    s_lshl_b32 s62, s2, 6
    s_add_u32 s62, s62, 4096
    v_lshl_add_u32 v30, v37, 4, s62
    v_add_u32 v31, 16384, v29
    v_cmp_gt_u32 vcc, 384, v0
    s_nop 1
    v_cndmask_b32 v30, v30, v31, vcc
    v_mov_b32 v31, 0x3f803f80
    v_mov_b32 v60, 0
    v_mov_b32 v61, 0
    v_mov_b32 v62, 0
    v_mov_b32 v63, 0
    v_lshlrev_b32_e64 v32, 4, v2
    v_add_u32 v35, 110240, v32
    s_cmp_lg_u32 s48, 7
    s_cbranch_scc1 L_k1_nozero
    s_mov_b64 exec, 0xf
    s_nop 0
    ds_write_b128 v35, v[60:63] offset:4096
    ds_write_b128 v35, v[60:63] offset:12416
    ds_write_b128 v35, v[60:63] offset:16576
    ds_write_b128 v35, v[60:63] offset:8256
    ds_write_b128 v35, v[60:63] offset:20864
    ds_write_b128 v35, v[60:63] offset:25024
    s_mov_b32 exec_lo, -1
    ds_write_b128 v35, v[60:63] offset:25216
    ds_write_b128 v35, v[60:63] offset:29824
    s_mov_b64 exec, -1
L_k1_nozero:
    v_and_b32 v33, 15, v2
    v_lshrrev_b32 v34, 4, v2
    v_mul_u32_u24 v224, 1040, v33
    v_lshl_add_u32 v224, v34, 8, v224
    v_lshlrev_b32 v35, 3, v34
    v_sub_u32 v35, v35, v33
    v_add_u32 v35, 2031, v35
    v_and_b32 v36, 1, v35
    v_and_b32 v35, -2, v35
    v_mul_u32_u24 v36, 4160, v36
    v_lshl_add_u32 v242, v35, 1, v36
    v_lshlrev_b32_e64 v36, 5, v33
    v_lshl_add_u32 v228, v34, 4, v36
    v_lshl_add_u32 v235, v34, 3, v36
    v_lshrrev_b32 v35, 2, v2
    v_lshrrev_b32 v36, 3, v2
    v_mul_u32_u24 v36, 28672, v36
    v_and_b32_e64 v38, 7, v2
    v_lshl_add_u32 v229, v38, 4, v36
    v_mul_u32_u24 v36, 224, v35
    v_lshl_add_u32 v239, v37, 3, v36
    v_and_b32 v15, 255, v0
    v_mul_u32_u24 v36, 4682, v15
    v_lshrrev_b32_e64 v36, 16, v36
    v_mul_u32_u24 v36, 672, v36
    v_lshl_add_u32 v238, v15, 4, v36
    v_add_u32 v15, 256, v15
    v_min_u32 v15, 447, v15
    v_mul_u32_u24 v36, 4682, v15
    v_lshrrev_b32_e64 v36, 16, v36
    v_mul_u32_u24 v36, 672, v36
    v_lshl_add_u32 v255, v15, 4, v36
    s_mov_b32 s72, s40
    s_mov_b32 s73, s41
    s_mov_b32 s74, 1605632
    s_mov_b32 s75, 0x00020000
    s_lshr_b32 s64, s51, 2
    s_and_b32 s66, s51, 3
    s_mul_i32 s70, s64, 28672
    s_mul_i32 s67, s66, 224
    s_add_u32 s70, s70, s67
    s_mul_i32 s66, s66, 392
    s_add_u32 s66, s66, s64
    s_lshl_b32 s66, s66, 10
    s_lshl_b32 s64, s51, 7
    s_lshl_b32 s65, s51, 13
    v_cmp_lt_u32 vcc, 6, v2
    v_mov_b32 v36, 2688
    s_nop 0
    v_cndmask_b32 v36, 0, v36, vcc
    v_lshl_add_u32 v36, v2, 7, v36
    s_lshl_b32 s67, s56, 3
    s_add_u32 s67, s67, s48
    s_mul_i32 s67, s67, 7168
    s_and_b32 s71, s2, 3
    s_mul_i32 s71, s71, 896
    s_add_u32 s67, s67, s71
    v_add_u32 v241, s67, v36
    v_cmp_gt_u32_e64 vcc, 56, v2
    s_waitcnt lgkmcnt(0)
    s_mul_i32 s53, s53, 0x9e3779b1
    s_add_u32 s53, s53, 0x7f4a7c15
    v_mov_b32 v41, s53
    v_mov_b32 v43, s53
    v_mov_b32 v45, s53
    v_mov_b32 v47, s53
    s_mov_b32 m0, s76
    v_add_u32 v225, s77, v224
    v_add_u32 v224, s78, v224
    v_add_u32 v233, s79, v32
    v_add_u32_e64 v234, s80, v32
    v_lshl_add_u32 v226, v2, 2, s81
    v_add_u32 v227, s82, v32
    v_add_u32 v242, s83, v242
    v_subrev_u32 v243, 1024, v242
    v_subrev_u32 v244, 2048, v242
    v_subrev_u32 v245, 3072, v242
    v_add_u32 v228, s84, v228
    v_add_u32 v236, s85, v235
    s_add_u32 s65, s65, s86
    v_add_u32 v237, s65, v235
    v_add_u32 v235, s87, v235
    s_add_u32 s64, s64, s88
    v_add_u32_e64 v229, s64, v229
    v_add_u32 v230, 229376, v229
    v_add_u32_e64 v231, s89, v32
    v_lshl_add_u32 v232, v2, 2, s90
    v_add_u32 v239, s91, v239
    s_add_u32 s66, s66, s4
    v_add_u32 v240, s66, v32
    s_mov_b32 s68, s5
    s_mov_b32 s69, s6
    s_waitcnt vmcnt(9)
    ds_write_b128 v27, v[16:19]
    v_cndmask_b32 v16, 0, v16, vcc
    v_cndmask_b32 v17, 0, v17, vcc
    v_cndmask_b32 v18, 0, v18, vcc
    v_cndmask_b32 v19, 0, v19, vcc
    v_dot2_f32_bf16 v48, v16, v31, 0
    v_dot2_f32_bf16 v49, v16, v16, 0
    v_dot2_f32_bf16 v48, v17, v31, v48
    v_dot2_f32_bf16 v49, v17, v17, v49
    v_dot2_f32_bf16 v48, v18, v31, v48
    v_dot2_f32_bf16 v49, v18, v18, v49
    v_dot2_f32_bf16 v48, v19, v31, v48
    v_dot2_f32_bf16 v49, v19, v19, v49
    s_nop 2
    v_add_f32_dpp v48, v48, v48 quad_perm:[1,0,3,2] row_mask:0xf bank_mask:0xf
    v_add_f32_dpp v49, v49, v49 quad_perm:[1,0,3,2] row_mask:0xf bank_mask:0xf
    s_nop 0
    v_add_f32_dpp v48, v48, v48 quad_perm:[2,3,0,1] row_mask:0xf bank_mask:0xf
    v_add_f32_dpp v49, v49, v49 quad_perm:[2,3,0,1] row_mask:0xf bank_mask:0xf
    s_nop 0
    v_add_f32_dpp v48, v48, v48 row_half_mirror row_mask:0xf bank_mask:0xf
    v_add_f32_dpp v49, v49, v49 row_half_mirror row_mask:0xf bank_mask:0xf
    s_nop 0
    v_add_f32_dpp v48, v48, v48 row_mirror row_mask:0xf bank_mask:0xf
    v_add_f32_dpp v49, v49, v49 row_mirror row_mask:0xf bank_mask:0xf
    s_nop 0
    v_add_f32_dpp v48, v48, v48 row_bcast:15 row_mask:0xa bank_mask:0xf
    v_add_f32_dpp v49, v49, v49 row_bcast:15 row_mask:0xa bank_mask:0xf
    s_nop 0
    v_add_f32_dpp v48, v48, v48 row_bcast:31 row_mask:0xc bank_mask:0xf
    v_add_f32_dpp v49, v49, v49 row_bcast:31 row_mask:0xc bank_mask:0xf
    v_mul_f32 v48, 0x3b124925, v48
    v_mul_f32 v49, 0x3b124925, v49
    v_fma_f32 v49, -v48, v48, v49
    v_max_f32_e64 v49, 0, v49
    v_cvt_pk_bf16_f32 v49, v49, v49
    v_lshlrev_b32_e64 v49, 16, v49
    v_add_f32 v49, 0x3727c5ac, v49
    v_cvt_pk_bf16_f32 v49, v49, v49
    v_lshlrev_b32 v49, 16, v49
    v_sqrt_f32_e64 v49, v49
    s_nop 0
    v_cvt_pk_bf16_f32 v50, v48, v49
    s_mov_b32 exec_lo, 0
    s_mov_b32 exec_hi, 0x80000000
    ds_write_b32 v27, v50 offset:16
    s_mov_b64 exec, -1
    s_waitcnt lgkmcnt(0)
    s_barrier
    ds_read_b32 v40, v28
    ds_read_b32 v42, v28 offset:912
    ds_read_b32 v44, v26 offset:512
    ds_read_b32 v46, v26 offset:1424
    s_lshl_b32 s63, s49, 4
    s_lshr_b32 s57, s57, s63
    s_lshl_b32 s57, s57, 16
    s_lshr_b32 s58, s58, s63
    s_lshl_b32 s58, s58, 16
    v_mov_b32 v36, s57
    v_mov_b32 v37, 0x3fb8aa3b
    v_mul_f32_e64 v38, v36, v37
    v_fma_f32 v39, v36, v37, -v38
    s_waitcnt lgkmcnt(2)
    global_store_dwordx4 v29, v[40:43], s[46:47] sc1
    s_waitcnt lgkmcnt(0)
    global_store_dwordx4 v30, v[44:47], s[46:47] sc1
    s_cmp_ge_u32 s55, 28
    s_cbranch_scc1 L_k1_aux
    s_cmp_eq_u32 s49, 0
    s_cbranch_scc0 L_k1_lowprio
    s_setprio 2
L_k1_lowprio:
    v_fmac_f32 v39, 0x32a57060, v36
    v_exp_f32 v38, v38
    v_mul_f32 v39, 0x3f317218, v39
    v_fma_f32 v38, v38, v39, v38
    v_cvt_pk_bf16_f32 v38, v38, v38
    v_lshlrev_b32 v36, 16, v38
    s_waitcnt vmcnt(2)
    v_lshlrev_b32 v8, 16, v8
    v_lshlrev_b32 v9, 16, v9
    v_lshlrev_b32 v10, 16, v10
    v_lshlrev_b32 v11, 16, v11
    v_lshlrev_b32 v12, 16, v12
    v_lshlrev_b32 v13, 16, v13
    v_mul_f32 v8, v36, v8
    v_mul_f32 v9, v36, v9
    v_mul_f32 v10, v36, v10
    v_mul_f32 v11, v36, v11
    v_mul_f32 v8, v37, v8
    v_mul_f32 v9, 0.15915494, v9
    v_mul_f32 v52, 0x41000000, v8
    v_mul_f32 v53, 0x41000000, v9
    v_mul_f32 v54, 0x43800000, v8
    v_mul_f32 v55, 0x43800000, v9
    v_fract_f32 v57, v9
    v_fract_f32 v53, v53
    v_fract_f32 v55, v55
    v_exp_f32 v52, v52
    v_cos_f32 v134, v53
    v_sin_f32 v135, v53
    v_exp_f32 v56, v8
    v_cos_f32 v132, v57
    v_sin_f32 v133, v57
    v_exp_f32 v54, v54
    v_cos_f32 v136, v55
    v_sin_f32 v137, v55
    v_pk_mul_f32 v[134:135], v[134:135], v[52:53] op_sel:[0,0] op_sel_hi:[1,0]
    v_pk_mul_f32 v[132:133], v[132:133], v[56:57] op_sel:[0,0] op_sel_hi:[1,0]
    v_pk_mul_f32 v[136:137], v[136:137], v[54:55] op_sel:[0,0] op_sel_hi:[1,0]
    v_mov_b32 v122, 0x00003f80
    ds_write_addtid_b32 v122 offset:0
    v_pk_mul_f32 v[60:61], v[12:13], v[10:11] op_sel:[0,0] op_sel_hi:[1,0]
    v_pk_mul_f32 v[84:85], v[134:135], v[134:135] op_sel:[0,0] op_sel_hi:[1,0]
    v_pk_mul_f32 v[138:139], v[132:133], v[132:133] op_sel:[0,0] op_sel_hi:[1,0]
    v_pk_mul_f32 v[142:143], v[136:137], v[136:137] op_sel:[0,0] op_sel_hi:[1,0]
    v_pk_fma_f32 v[60:61], v[12:13], v[10:11], v[60:61] op_sel:[1,1,0] op_sel_hi:[0,1,1] neg_lo:[1,0,0]
    v_pk_fma_f32 v[84:85], v[134:135], v[134:135], v[84:85] op_sel:[1,1,0] op_sel_hi:[0,1,1] neg_lo:[1,0,0]
    v_pk_fma_f32 v[138:139], v[132:133], v[132:133], v[138:139] op_sel:[1,1,0] op_sel_hi:[0,1,1] neg_lo:[1,0,0]
    v_pk_fma_f32 v[142:143], v[136:137], v[136:137], v[142:143] op_sel:[1,1,0] op_sel_hi:[0,1,1] neg_lo:[1,0,0]
    v_cvt_pk_bf16_f32 v124, v84, v85
    v_cvt_pk_bf16_f32 v125, v134, v135
    ds_write_addtid_b32 v124 offset:2080
    ds_write_addtid_b32 v125 offset:1040
    v_xor_b32 v61, 0x80000000, v61
    v_pk_mul_f32 v[86:87], v[84:85], v[134:135] op_sel:[0,0] op_sel_hi:[1,0]
    v_pk_mul_f32 v[120:121], v[84:85], v[84:85] op_sel:[0,0] op_sel_hi:[1,0]
    v_pk_mul_f32 v[140:141], v[138:139], v[138:139] op_sel:[0,0] op_sel_hi:[1,0]
    v_pk_mul_f32 v[62:63], v[60:61], v[132:133] op_sel:[0,0] op_sel_hi:[1,0]
    v_pk_mul_f32 v[64:65], v[60:61], v[138:139] op_sel:[0,0] op_sel_hi:[1,0]
    v_pk_mul_f32 v[76:77], v[60:61], v[134:135] op_sel:[0,0] op_sel_hi:[1,0]
    v_pk_fma_f32 v[86:87], v[84:85], v[134:135], v[86:87] op_sel:[1,1,0] op_sel_hi:[0,1,1] neg_lo:[1,0,0]
    v_pk_fma_f32 v[120:121], v[84:85], v[84:85], v[120:121] op_sel:[1,1,0] op_sel_hi:[0,1,1] neg_lo:[1,0,0]
    v_pk_fma_f32 v[140:141], v[138:139], v[138:139], v[140:141] op_sel:[1,1,0] op_sel_hi:[0,1,1] neg_lo:[1,0,0]
    v_pk_fma_f32 v[62:63], v[60:61], v[132:133], v[62:63] op_sel:[1,1,0] op_sel_hi:[0,1,1] neg_hi:[1,0,0]
    v_pk_fma_f32 v[64:65], v[60:61], v[138:139], v[64:65] op_sel:[1,1,0] op_sel_hi:[0,1,1] neg_hi:[1,0,0]
    v_pk_fma_f32 v[76:77], v[60:61], v[134:135], v[76:77] op_sel:[1,1,0] op_sel_hi:[0,1,1] neg_hi:[1,0,0]
    v_cvt_pk_bf16_f32 v126, v86, v87
    v_cvt_pk_bf16_f32 v127, v120, v121
    v_cvt_pk_bf16_f32 v128, v62, v63
    v_cvt_pk_bf16_f32 v129, v64, v65
    v_cvt_pk_bf16_f32 v130, v76, v77
    v_cvt_pk_bf16_f32 v131, v60, v61
    ds_write_addtid_b32 v126 offset:3120
    ds_write_addtid_b32 v127 offset:4160
    ds_write_addtid_b32 v128 offset:33280
    ds_write_addtid_b32 v129 offset:34320
    ds_write_addtid_b32 v130 offset:40560
    ds_write_addtid_b32 v131 offset:54080
    v_pk_mul_f32 v[90:91], v[134:135], v[120:121] op_sel:[0,0] op_sel_hi:[1,0]
    v_pk_mul_f32 v[92:93], v[84:85], v[120:121] op_sel:[0,0] op_sel_hi:[1,0]
    v_pk_mul_f32 v[94:95], v[86:87], v[120:121] op_sel:[0,0] op_sel_hi:[1,0]
    v_pk_mul_f32 v[66:67], v[62:63], v[138:139] op_sel:[0,0] op_sel_hi:[1,0]
    v_pk_mul_f32 v[68:69], v[60:61], v[140:141] op_sel:[0,0] op_sel_hi:[1,0]
    v_pk_mul_f32 v[70:71], v[62:63], v[140:141] op_sel:[0,0] op_sel_hi:[1,0]
    v_pk_mul_f32 v[72:73], v[64:65], v[140:141] op_sel:[0,0] op_sel_hi:[1,0]
    v_pk_fma_f32 v[90:91], v[134:135], v[120:121], v[90:91] op_sel:[1,1,0] op_sel_hi:[0,1,1] neg_lo:[1,0,0]
    v_pk_fma_f32 v[92:93], v[84:85], v[120:121], v[92:93] op_sel:[1,1,0] op_sel_hi:[0,1,1] neg_lo:[1,0,0]
    v_pk_fma_f32 v[94:95], v[86:87], v[120:121], v[94:95] op_sel:[1,1,0] op_sel_hi:[0,1,1] neg_lo:[1,0,0]
    v_pk_fma_f32 v[66:67], v[62:63], v[138:139], v[66:67] op_sel:[1,1,0] op_sel_hi:[0,1,1] neg_hi:[1,0,0]
    v_pk_fma_f32 v[68:69], v[60:61], v[140:141], v[68:69] op_sel:[1,1,0] op_sel_hi:[0,1,1] neg_hi:[1,0,0]
    v_pk_fma_f32 v[70:71], v[62:63], v[140:141], v[70:71] op_sel:[1,1,0] op_sel_hi:[0,1,1] neg_hi:[1,0,0]
    v_pk_fma_f32 v[72:73], v[64:65], v[140:141], v[72:73] op_sel:[1,1,0] op_sel_hi:[0,1,1] neg_hi:[1,0,0]
    v_cvt_pk_bf16_f32 v124, v90, v91
    v_cvt_pk_bf16_f32 v125, v92, v93
    v_cvt_pk_bf16_f32 v126, v94, v95
    v_cvt_pk_bf16_f32 v127, v66, v67
    v_cvt_pk_bf16_f32 v128, v68, v69
    v_cvt_pk_bf16_f32 v129, v70, v71
    v_cvt_pk_bf16_f32 v130, v72, v73
    ds_write_addtid_b32 v124 offset:5200
    ds_write_addtid_b32 v125 offset:6240
    ds_write_addtid_b32 v126 offset:7280
    ds_write_addtid_b32 v127 offset:35360
    ds_write_addtid_b32 v128 offset:36400
    ds_write_addtid_b32 v129 offset:37440
    ds_write_addtid_b32 v130 offset:38480
    v_pk_mul_f32 v[80:81], v[120:121], v[120:121] op_sel:[0,0] op_sel_hi:[1,0]
    v_pk_mul_f32 v[82:83], v[90:91], v[120:121] op_sel:[0,0] op_sel_hi:[1,0]
    v_pk_mul_f32 v[84:85], v[92:93], v[120:121] op_sel:[0,0] op_sel_hi:[1,0]
    v_pk_mul_f32 v[86:87], v[94:95], v[120:121] op_sel:[0,0] op_sel_hi:[1,0]
    v_pk_mul_f32 v[74:75], v[66:67], v[140:141] op_sel:[0,0] op_sel_hi:[1,0]
    v_pk_mul_f32 v[96:97], v[64:65], v[136:137] op_sel:[0,0] op_sel_hi:[1,0]
    v_pk_mul_f32 v[98:99], v[68:69], v[136:137] op_sel:[0,0] op_sel_hi:[1,0]
    v_pk_mul_f32 v[102:103], v[76:77], v[136:137] op_sel:[0,0] op_sel_hi:[1,0]
    v_pk_fma_f32 v[80:81], v[120:121], v[120:121], v[80:81] op_sel:[1,1,0] op_sel_hi:[0,1,1] neg_lo:[1,0,0]
    v_pk_fma_f32 v[82:83], v[90:91], v[120:121], v[82:83] op_sel:[1,1,0] op_sel_hi:[0,1,1] neg_lo:[1,0,0]
    v_pk_fma_f32 v[84:85], v[92:93], v[120:121], v[84:85] op_sel:[1,1,0] op_sel_hi:[0,1,1] neg_lo:[1,0,0]
    v_pk_fma_f32 v[86:87], v[94:95], v[120:121], v[86:87] op_sel:[1,1,0] op_sel_hi:[0,1,1] neg_lo:[1,0,0]
    v_pk_fma_f32 v[74:75], v[66:67], v[140:141], v[74:75] op_sel:[1,1,0] op_sel_hi:[0,1,1] neg_hi:[1,0,0]
    v_pk_fma_f32 v[96:97], v[64:65], v[136:137], v[96:97] op_sel:[1,1,0] op_sel_hi:[0,1,1] neg_hi:[1,0,0]
    v_pk_fma_f32 v[98:99], v[68:69], v[136:137], v[98:99] op_sel:[1,1,0] op_sel_hi:[0,1,1] neg_hi:[1,0,0]
    v_pk_fma_f32 v[102:103], v[76:77], v[136:137], v[102:103] op_sel:[1,1,0] op_sel_hi:[0,1,1] neg_hi:[1,0,0]
    v_cvt_pk_bf16_f32 v131, v80, v81
    v_cvt_pk_bf16_f32 v124, v82, v83
    v_cvt_pk_bf16_f32 v125, v84, v85
    v_cvt_pk_bf16_f32 v126, v86, v87
    v_cvt_pk_bf16_f32 v127, v74, v75
    v_cvt_pk_bf16_f32 v128, v96, v97
    v_cvt_pk_bf16_f32 v129, v98, v99
    v_cvt_pk_bf16_f32 v130, v102, v103
    ds_write_addtid_b32 v131 offset:8320
    ds_write_addtid_b32 v124 offset:9360
    ds_write_addtid_b32 v125 offset:10400
    ds_write_addtid_b32 v126 offset:11440
    ds_write_addtid_b32 v127 offset:39520
    ds_write_addtid_b32 v128 offset:41600
    ds_write_addtid_b32 v129 offset:42640
    ds_write_addtid_b32 v130 offset:44720
    v_pk_mul_f32 v[88:89], v[80:81], v[120:121] op_sel:[0,0] op_sel_hi:[1,0]
    v_pk_mul_f32 v[90:91], v[82:83], v[120:121] op_sel:[0,0] op_sel_hi:[1,0]
    v_pk_mul_f32 v[92:93], v[84:85], v[120:121] op_sel:[0,0] op_sel_hi:[1,0]
    v_pk_mul_f32 v[94:95], v[86:87], v[120:121] op_sel:[0,0] op_sel_hi:[1,0]
    v_pk_mul_f32 v[100:101], v[72:73], v[136:137] op_sel:[0,0] op_sel_hi:[1,0]
    v_pk_mul_f32 v[104:105], v[98:99], v[136:137] op_sel:[0,0] op_sel_hi:[1,0]
    v_pk_mul_f32 v[106:107], v[102:103], v[136:137] op_sel:[0,0] op_sel_hi:[1,0]
    v_pk_fma_f32 v[88:89], v[80:81], v[120:121], v[88:89] op_sel:[1,1,0] op_sel_hi:[0,1,1] neg_lo:[1,0,0]
    v_pk_fma_f32 v[90:91], v[82:83], v[120:121], v[90:91] op_sel:[1,1,0] op_sel_hi:[0,1,1] neg_lo:[1,0,0]
    v_pk_fma_f32 v[92:93], v[84:85], v[120:121], v[92:93] op_sel:[1,1,0] op_sel_hi:[0,1,1] neg_lo:[1,0,0]
    v_pk_fma_f32 v[94:95], v[86:87], v[120:121], v[94:95] op_sel:[1,1,0] op_sel_hi:[0,1,1] neg_lo:[1,0,0]
    v_pk_fma_f32 v[100:101], v[72:73], v[136:137], v[100:101] op_sel:[1,1,0] op_sel_hi:[0,1,1] neg_hi:[1,0,0]
    v_pk_fma_f32 v[104:105], v[98:99], v[136:137], v[104:105] op_sel:[1,1,0] op_sel_hi:[0,1,1] neg_hi:[1,0,0]
    v_pk_fma_f32 v[106:107], v[102:103], v[136:137], v[106:107] op_sel:[1,1,0] op_sel_hi:[0,1,1] neg_hi:[1,0,0]
    v_cvt_pk_bf16_f32 v131, v88, v89
    v_cvt_pk_bf16_f32 v124, v90, v91
    v_cvt_pk_bf16_f32 v125, v92, v93
    v_cvt_pk_bf16_f32 v126, v94, v95
    v_cvt_pk_bf16_f32 v127, v100, v101
    v_cvt_pk_bf16_f32 v128, v104, v105
    v_cvt_pk_bf16_f32 v129, v106, v107
    ds_write_addtid_b32 v131 offset:12480
    ds_write_addtid_b32 v124 offset:13520
    ds_write_addtid_b32 v125 offset:14560
    ds_write_addtid_b32 v126 offset:15600
    ds_write_addtid_b32 v127 offset:43680
    ds_write_addtid_b32 v128 offset:45760
    ds_write_addtid_b32 v129 offset:46800
    v_pk_mul_f32 v[80:81], v[88:89], v[120:121] op_sel:[0,0] op_sel_hi:[1,0]
    v_pk_mul_f32 v[82:83], v[90:91], v[120:121] op_sel:[0,0] op_sel_hi:[1,0]
    v_pk_mul_f32 v[84:85], v[92:93], v[120:121] op_sel:[0,0] op_sel_hi:[1,0]
    v_pk_mul_f32 v[86:87], v[94:95], v[120:121] op_sel:[0,0] op_sel_hi:[1,0]
    v_pk_mul_f32 v[108:109], v[98:99], v[142:143] op_sel:[0,0] op_sel_hi:[1,0]
    v_pk_mul_f32 v[110:111], v[102:103], v[142:143] op_sel:[0,0] op_sel_hi:[1,0]
    v_pk_fma_f32 v[80:81], v[88:89], v[120:121], v[80:81] op_sel:[1,1,0] op_sel_hi:[0,1,1] neg_lo:[1,0,0]
    v_pk_fma_f32 v[82:83], v[90:91], v[120:121], v[82:83] op_sel:[1,1,0] op_sel_hi:[0,1,1] neg_lo:[1,0,0]
    v_pk_fma_f32 v[84:85], v[92:93], v[120:121], v[84:85] op_sel:[1,1,0] op_sel_hi:[0,1,1] neg_lo:[1,0,0]
    v_pk_fma_f32 v[86:87], v[94:95], v[120:121], v[86:87] op_sel:[1,1,0] op_sel_hi:[0,1,1] neg_lo:[1,0,0]
    v_pk_fma_f32 v[108:109], v[98:99], v[142:143], v[108:109] op_sel:[1,1,0] op_sel_hi:[0,1,1] neg_hi:[1,0,0]
    v_pk_fma_f32 v[110:111], v[102:103], v[142:143], v[110:111] op_sel:[1,1,0] op_sel_hi:[0,1,1] neg_hi:[1,0,0]
    v_cvt_pk_bf16_f32 v130, v80, v81
    v_cvt_pk_bf16_f32 v131, v82, v83
    v_cvt_pk_bf16_f32 v124, v84, v85
    v_cvt_pk_bf16_f32 v125, v86, v87
    v_cvt_pk_bf16_f32 v126, v108, v109
    v_cvt_pk_bf16_f32 v127, v110, v111
    ds_write_addtid_b32 v130 offset:16640
    ds_write_addtid_b32 v131 offset:17680
    ds_write_addtid_b32 v124 offset:18720
    ds_write_addtid_b32 v125 offset:19760
    ds_write_addtid_b32 v126 offset:47840
    ds_write_addtid_b32 v127 offset:48880
    s_cmp_eq_u32 s49, 0
    s_cbranch_scc1 L_k1_nob1
    s_barrier
    s_setprio 3
    global_load_dwordx4 v[28:31], v229, s[46:47] sc1
    global_load_dwordx4 v[32:35], v230, s[46:47] sc1
    global_load_dwordx4 v[36:39], v231, s[46:47] sc1
    global_load_dwordx4 v[40:43], v231, s[46:47] offset:1024 sc1
L_k1_nob1:
    v_pk_mul_f32 v[88:89], v[80:81], v[120:121] op_sel:[0,0] op_sel_hi:[1,0]
    v_pk_mul_f32 v[90:91], v[82:83], v[120:121] op_sel:[0,0] op_sel_hi:[1,0]
    v_pk_mul_f32 v[92:93], v[84:85], v[120:121] op_sel:[0,0] op_sel_hi:[1,0]
    v_pk_mul_f32 v[94:95], v[86:87], v[120:121] op_sel:[0,0] op_sel_hi:[1,0]
    v_pk_mul_f32 v[112:113], v[106:107], v[142:143] op_sel:[0,0] op_sel_hi:[1,0]
    v_pk_mul_f32 v[114:115], v[110:111], v[142:143] op_sel:[0,0] op_sel_hi:[1,0]
    v_pk_fma_f32 v[88:89], v[80:81], v[120:121], v[88:89] op_sel:[1,1,0] op_sel_hi:[0,1,1] neg_lo:[1,0,0]
    v_pk_fma_f32 v[90:91], v[82:83], v[120:121], v[90:91] op_sel:[1,1,0] op_sel_hi:[0,1,1] neg_lo:[1,0,0]
    v_pk_fma_f32 v[92:93], v[84:85], v[120:121], v[92:93] op_sel:[1,1,0] op_sel_hi:[0,1,1] neg_lo:[1,0,0]
    v_pk_fma_f32 v[94:95], v[86:87], v[120:121], v[94:95] op_sel:[1,1,0] op_sel_hi:[0,1,1] neg_lo:[1,0,0]
    v_pk_fma_f32 v[112:113], v[106:107], v[142:143], v[112:113] op_sel:[1,1,0] op_sel_hi:[0,1,1] neg_hi:[1,0,0]
    v_pk_fma_f32 v[114:115], v[110:111], v[142:143], v[114:115] op_sel:[1,1,0] op_sel_hi:[0,1,1] neg_hi:[1,0,0]
    v_cvt_pk_bf16_f32 v128, v88, v89
    v_cvt_pk_bf16_f32 v129, v90, v91
    v_cvt_pk_bf16_f32 v130, v92, v93
    v_cvt_pk_bf16_f32 v131, v94, v95
    v_cvt_pk_bf16_f32 v124, v112, v113
    v_cvt_pk_bf16_f32 v125, v114, v115
    ds_write_addtid_b32 v128 offset:20800
    ds_write_addtid_b32 v129 offset:21840
    ds_write_addtid_b32 v130 offset:22880
    ds_write_addtid_b32 v131 offset:23920
    ds_write_addtid_b32 v124 offset:49920
    ds_write_addtid_b32 v125 offset:50960
    v_pk_mul_f32 v[80:81], v[88:89], v[120:121] op_sel:[0,0] op_sel_hi:[1,0]
    v_pk_mul_f32 v[82:83], v[90:91], v[120:121] op_sel:[0,0] op_sel_hi:[1,0]
    v_pk_mul_f32 v[84:85], v[92:93], v[120:121] op_sel:[0,0] op_sel_hi:[1,0]
    v_pk_mul_f32 v[86:87], v[94:95], v[120:121] op_sel:[0,0] op_sel_hi:[1,0]
    v_pk_mul_f32 v[116:117], v[112:113], v[142:143] op_sel:[0,0] op_sel_hi:[1,0]
    v_pk_mul_f32 v[118:119], v[114:115], v[142:143] op_sel:[0,0] op_sel_hi:[1,0]
    v_pk_fma_f32 v[80:81], v[88:89], v[120:121], v[80:81] op_sel:[1,1,0] op_sel_hi:[0,1,1] neg_lo:[1,0,0]
    v_pk_fma_f32 v[82:83], v[90:91], v[120:121], v[82:83] op_sel:[1,1,0] op_sel_hi:[0,1,1] neg_lo:[1,0,0]
    v_pk_fma_f32 v[84:85], v[92:93], v[120:121], v[84:85] op_sel:[1,1,0] op_sel_hi:[0,1,1] neg_lo:[1,0,0]
    v_pk_fma_f32 v[86:87], v[94:95], v[120:121], v[86:87] op_sel:[1,1,0] op_sel_hi:[0,1,1] neg_lo:[1,0,0]
    v_pk_fma_f32 v[116:117], v[112:113], v[142:143], v[116:117] op_sel:[1,1,0] op_sel_hi:[0,1,1] neg_hi:[1,0,0]
    v_pk_fma_f32 v[118:119], v[114:115], v[142:143], v[118:119] op_sel:[1,1,0] op_sel_hi:[0,1,1] neg_hi:[1,0,0]
    v_cvt_pk_bf16_f32 v126, v80, v81
    v_cvt_pk_bf16_f32 v127, v82, v83
    v_cvt_pk_bf16_f32 v128, v84, v85
    v_cvt_pk_bf16_f32 v129, v86, v87
    v_cvt_pk_bf16_f32 v130, v116, v117
    v_cvt_pk_bf16_f32 v131, v118, v119
    ds_write_addtid_b32 v126 offset:24960
    ds_write_addtid_b32 v127 offset:26000
    ds_write_addtid_b32 v128 offset:27040
    ds_write_addtid_b32 v129 offset:28080
    ds_write_addtid_b32 v130 offset:52000
    ds_write_addtid_b32 v131 offset:53040
    v_pk_mul_f32 v[88:89], v[80:81], v[120:121] op_sel:[0,0] op_sel_hi:[1,0]
    v_pk_mul_f32 v[90:91], v[82:83], v[120:121] op_sel:[0,0] op_sel_hi:[1,0]
    v_pk_mul_f32 v[92:93], v[84:85], v[120:121] op_sel:[0,0] op_sel_hi:[1,0]
    v_pk_mul_f32 v[94:95], v[86:87], v[120:121] op_sel:[0,0] op_sel_hi:[1,0]
    v_pk_fma_f32 v[88:89], v[80:81], v[120:121], v[88:89] op_sel:[1,1,0] op_sel_hi:[0,1,1] neg_lo:[1,0,0]
    v_pk_fma_f32 v[90:91], v[82:83], v[120:121], v[90:91] op_sel:[1,1,0] op_sel_hi:[0,1,1] neg_lo:[1,0,0]
    v_pk_fma_f32 v[92:93], v[84:85], v[120:121], v[92:93] op_sel:[1,1,0] op_sel_hi:[0,1,1] neg_lo:[1,0,0]
    v_pk_fma_f32 v[94:95], v[86:87], v[120:121], v[94:95] op_sel:[1,1,0] op_sel_hi:[0,1,1] neg_lo:[1,0,0]
    v_cvt_pk_bf16_f32 v124, v88, v89
    v_cvt_pk_bf16_f32 v125, v90, v91
    v_cvt_pk_bf16_f32 v126, v92, v93
    v_cvt_pk_bf16_f32 v127, v94, v95
    ds_write_addtid_b32 v124 offset:29120
    ds_write_addtid_b32 v125 offset:30160
    ds_write_addtid_b32 v126 offset:31200
    ds_write_addtid_b32 v127 offset:32240
    s_waitcnt lgkmcnt(0)
    s_barrier
    ds_read_b128 v[96:99], v224 offset:0
    ds_read_b128 v[100:103], v225 offset:0
    ds_read_b128 v[104:107], v224 offset:16
    ds_read_b128 v[108:111], v225 offset:16
    ds_read_b128 v[112:115], v224 offset:32
    ds_read_b128 v[116:119], v225 offset:32
    ds_read_b128 v[120:123], v224 offset:48
    ds_read_b128 v[124:127], v225 offset:48
    ds_read_b128 v[128:131], v224 offset:64
    ds_read_b128 v[132:135], v225 offset:64
    ds_read_b128 v[136:139], v224 offset:80
    ds_read_b128 v[140:143], v225 offset:80
    ds_read_b128 v[144:147], v224 offset:96
    ds_read_b128 v[148:151], v225 offset:96
    s_cmp_eq_u32 s49, 0
    s_cbranch_scc0 L_k1_noh0
    global_load_dwordx4 v[28:31], v229, s[46:47] sc1
    global_load_dwordx4 v[32:35], v230, s[46:47] sc1
    global_load_dwordx4 v[36:39], v231, s[46:47] sc1
    global_load_dwordx4 v[40:43], v231, s[46:47] offset:1024 sc1
L_k1_noh0:
    ds_read_b128 v[152:155], v224 offset:112
    ds_read_b128 v[156:159], v225 offset:112
    ds_read_b128 v[160:163], v224 offset:128
    ds_read_b128 v[164:167], v225 offset:128
    ds_read_b128 v[168:171], v224 offset:144
    ds_read_b128 v[172:175], v225 offset:144
    ds_read_b128 v[176:179], v224 offset:160
    ds_read_b128 v[180:183], v225 offset:160
    ds_read_b128 v[184:187], v224 offset:176
    ds_read_b128 v[188:191], v225 offset:176
    ds_read_b128 v[192:195], v224 offset:192
    ds_read_b128 v[196:199], v225 offset:192
    ds_read_b128 v[200:203], v224 offset:208
    ds_read_b128 v[204:207], v225 offset:208
    ds_read_b128 v[208:211], v224 offset:224
    ds_read_b128 v[212:215], v225 offset:224
    ds_read_b128 v[216:219], v224 offset:240
    ds_read_b128 v[220:223], v225 offset:240
    s_cmp_eq_u32 s49, 0
    s_cbranch_scc0 L_k1_nob4
    s_barrier
L_k1_nob4:
    s_waitcnt lgkmcnt(15)
    v_mfma_f32_16x16x32_bf16 v[92:95], v[96:99], v[100:103], 0
    s_waitcnt lgkmcnt(15)
    v_mfma_f32_16x16x32_bf16 v[92:95], v[104:107], v[108:111], v[92:95]
    s_waitcnt lgkmcnt(15)
    v_mfma_f32_16x16x32_bf16 v[92:95], v[112:115], v[116:119], v[92:95]
    s_waitcnt lgkmcnt(15)
    v_mfma_f32_16x16x32_bf16 v[92:95], v[120:123], v[124:127], v[92:95]
    s_waitcnt lgkmcnt(15)
    v_mfma_f32_16x16x32_bf16 v[92:95], v[128:131], v[132:135], v[92:95]
    s_waitcnt lgkmcnt(15)
    v_mfma_f32_16x16x32_bf16 v[92:95], v[136:139], v[140:143], v[92:95]
    s_waitcnt lgkmcnt(15)
    v_mfma_f32_16x16x32_bf16 v[92:95], v[144:147], v[148:151], v[92:95]
    s_waitcnt lgkmcnt(15)
    v_mfma_f32_16x16x32_bf16 v[92:95], v[152:155], v[156:159], v[92:95]
    s_waitcnt lgkmcnt(14)
    v_mfma_f32_16x16x32_bf16 v[92:95], v[160:163], v[164:167], v[92:95]
    s_waitcnt lgkmcnt(12)
    v_mfma_f32_16x16x32_bf16 v[92:95], v[168:171], v[172:175], v[92:95]
    s_waitcnt lgkmcnt(10)
    v_mfma_f32_16x16x32_bf16 v[92:95], v[176:179], v[180:183], v[92:95]
    s_waitcnt lgkmcnt(8)
    v_mfma_f32_16x16x32_bf16 v[92:95], v[184:187], v[188:191], v[92:95]
    s_waitcnt lgkmcnt(6)
    v_mfma_f32_16x16x32_bf16 v[92:95], v[192:195], v[196:199], v[92:95]
    s_waitcnt lgkmcnt(4)
    v_mfma_f32_16x16x32_bf16 v[92:95], v[200:203], v[204:207], v[92:95]
    s_waitcnt lgkmcnt(2)
    v_mfma_f32_16x16x32_bf16 v[92:95], v[208:211], v[212:215], v[92:95]
    s_waitcnt lgkmcnt(0)
    v_mfma_f32_16x16x32_bf16 v[92:95], v[216:219], v[220:223], v[92:95]
    v_and_b32 v246, 0xffff, v20
    v_lshrrev_b32 v247, 16, v20
    v_and_b32 v248, 0xffff, v21
    v_lshrrev_b32_e64 v249, 16, v21
    v_and_b32 v250, 0xffff, v22
    v_lshrrev_b32_e64 v251, 16, v22
    v_and_b32 v252, 0xffff, v23
    v_lshrrev_b32 v253, 16, v23
    v_add_u32 v254, s68, v24
    v_add_u32 v246, s68, v246
    v_add_u32 v247, s68, v247
    v_add_u32 v248, s68, v248
    v_add_u32 v249, s68, v249
    v_add_u32 v250, s68, v250
    v_add_u32 v251, s68, v251
    v_add_u32 v252, s68, v252
    v_add_u32 v253, s68, v253
    ds_write2st64_b32 v226, v92, v93 offset0:0 offset1:1
    ds_write2st64_b32 v226, v94, v95 offset0:2 offset1:3
    s_waitcnt lgkmcnt(0)
    s_barrier
    ds_read_b32 v70, v246
    ds_read_b32 v71, v247
    ds_read_b32 v72, v248
    ds_read_b32 v73, v249
    ds_read_b32 v74, v250
    ds_read_b32 v75, v251
    ds_read_b32 v76, v252
    ds_read_b32 v77, v253
    ds_read_b32 v78, v254
    s_waitcnt lgkmcnt(0)
    s_nop 0
    v_cvt_pk_bf16_f32 v80, v70, v71
    v_cvt_pk_bf16_f32 v84, v71, v72
    v_cvt_pk_bf16_f32 v81, v72, v73
    v_cvt_pk_bf16_f32 v85, v73, v74
    v_cvt_pk_bf16_f32 v82, v74, v75
    v_cvt_pk_bf16_f32 v86, v75, v76
    v_cvt_pk_bf16_f32 v83, v76, v77
    v_cvt_pk_bf16_f32 v87, v77, v78
    ds_write_b128 v227, v[80:83]
    ds_write_b128 v227, v[84:87] offset:4160
L_k1_pollb:
    s_waitcnt vmcnt(0)
    v_xor_b32 v24, s53, v37
    v_xor_b32 v25, s53, v39
    v_or_b32 v24, v24, v25
    v_xor_b32 v25, s53, v41
    v_or_b32 v24, v24, v25
    v_xor_b32 v25, s53, v43
    v_or_b32 v24, v24, v25
    v_xor_b32 v25, s53, v29
    v_or_b32 v24, v24, v25
    v_xor_b32 v25, s53, v31
    v_or_b32 v24, v24, v25
    v_xor_b32 v25, s53, v33
    v_or_b32 v24, v24, v25
    v_xor_b32 v25, s53, v35
    v_or_b32 v24, v24, v25
    v_cmp_ne_u32 vcc, 0, v24
    s_cbranch_vccz L_k1_polldoneb
    global_load_dwordx4 v[28:31], v229, s[46:47] sc1
    global_load_dwordx4 v[32:35], v230, s[46:47] sc1
    global_load_dwordx4 v[36:39], v231, s[46:47] sc1
    global_load_dwordx4 v[40:43], v231, s[46:47] offset:1024 sc1
    s_branch L_k1_pollb
L_k1_polldoneb:
    v_and_b32 v8, 0xffff0000, v36
    v_lshlrev_b32 v12, 16, v36
    v_lshlrev_b32_e64 v16, 16, v28
    v_and_b32 v20, 0xffff0000, v28
    v_and_b32 v9, 0xffff0000, v38
    v_lshlrev_b32 v13, 16, v38
    v_lshlrev_b32 v17, 16, v30
    v_and_b32 v21, 0xffff0000, v30
    v_and_b32 v10, 0xffff0000, v40
    v_lshlrev_b32 v14, 16, v40
    v_lshlrev_b32 v18, 16, v32
    v_and_b32 v22, 0xffff0000, v32
    v_and_b32 v11, 0xffff0000, v42
    v_lshlrev_b32 v15, 16, v42
    v_lshlrev_b32 v19, 16, v34
    v_and_b32 v23, 0xffff0000, v34
    v_rcp_f32 v8, v8
    v_rcp_f32 v9, v9
    v_rcp_f32 v10, v10
    v_rcp_f32 v11, v11
    v_sub_f32 v16, v16, v12
    v_sub_f32 v20, v20, v12
    v_sub_f32 v17, v17, v13
    v_sub_f32 v21, v21, v13
    v_sub_f32 v18, v18, v14
    v_sub_f32 v22, v22, v14
    v_sub_f32 v19, v19, v15
    v_sub_f32 v23, v23, v15
    v_cvt_pk_bf16_f32 v16, v16, v20
    v_cvt_pk_bf16_f32 v17, v17, v21
    v_cvt_pk_bf16_f32 v18, v18, v22
    v_cvt_pk_bf16_f32 v19, v19, v23
    v_and_b32 v20, 0xffff0000, v16
    v_lshlrev_b32_e64 v16, 16, v16
    v_and_b32 v21, 0xffff0000, v17
    v_lshlrev_b32_e64 v17, 16, v17
    v_and_b32 v22, 0xffff0000, v18
    v_lshlrev_b32_e64 v18, 16, v18
    v_and_b32 v23, 0xffff0000, v19
    v_lshlrev_b32 v19, 16, v19
    v_mul_f32 v44, v16, v8
    v_mul_f32 v48, v20, v8
    v_mul_f32 v45, v17, v9
    v_mul_f32 v49, v21, v9
    v_mul_f32 v46, v18, v10
    v_mul_f32 v50, v22, v10
    v_mul_f32 v47, v19, v11
    v_mul_f32_e64 v51, v23, v11
    v_cvt_pk_bf16_f32 v44, v44, v45
    v_cvt_pk_bf16_f32 v45, v46, v47
    v_cvt_pk_bf16_f32 v48, v48, v49
    v_cvt_pk_bf16_f32 v49, v50, v51
    ds_write2st64_b32 v232, v44, v45 offset0:0 offset1:1
    ds_write2st64_b32 v232, v48, v49 offset0:18 offset1:19
    s_mov_b32 s66, 0x05040100
    s_mov_b32 s67, 0x07060302
    v_perm_b32 v52, v30, v28, s66
    v_perm_b32 v53, v34, v32, s66
    v_perm_b32 v54, v30, v28, s67
    v_perm_b32 v55, v34, v32, s67
    ds_write2st64_b32 v232, v52, v53 offset0:34 offset1:35
    ds_write2st64_b32 v232, v54, v55 offset0:50 offset1:51
    s_waitcnt lgkmcnt(0)
    s_barrier
    s_cmp_eq_u32 s49, 0
    s_cbranch_scc1 L_k1_nowd
    s_setprio 0
    s_mov_b32 m0, s69
    s_nop 0
    buffer_load_dwordx4 v238, s[72:75], s70 offen lds
    s_add_u32 m0, s69, 4096
    s_nop 0
    buffer_load_dwordx4 v255, s[72:75], s70 offen lds
L_k1_nowd:
    ds_read2_b32 v[64:65], v242 offset0:144 offset1:145
    ds_read2_b32 v[66:67], v242 offset0:146 offset1:147
    ds_read_b128 v[96:99], v228 offset:64
    ds_read2_b32 v[68:69], v242 offset0:16 offset1:17
    ds_read2_b32 v[70:71], v242 offset0:18 offset1:19
    ds_read_b128 v[100:103], v228 offset:576
    ds_read2_b32 v[72:73], v243 offset0:144 offset1:145
    ds_read2_b32 v[74:75], v243 offset0:146 offset1:147
    ds_read_b128 v[104:107], v228 offset:1088
    ds_read2_b32 v[76:77], v243 offset0:16 offset1:17
    ds_read2_b32 v[78:79], v243 offset0:18 offset1:19
    ds_read_b128 v[108:111], v228 offset:1600
    ds_read2_b32 v[80:81], v244 offset0:144 offset1:145
    ds_read2_b32 v[82:83], v244 offset0:146 offset1:147
    ds_read_b128 v[112:115], v228 offset:2112
    s_waitcnt lgkmcnt(12)
    v_mfma_f32_16x16x32_bf16 v[192:195], v[64:67], v[96:99], 0
    ds_read2_b32 v[84:85], v244 offset0:16 offset1:17
    s_waitcnt lgkmcnt(10)
    v_mfma_f32_16x16x32_bf16 v[196:199], v[68:71], v[96:99], 0
    ds_read2_b32 v[86:87], v244 offset0:18 offset1:19
    v_mfma_f32_16x16x32_bf16 v[200:203], v[68:71], v[100:103], 0
    ds_read_b128 v[116:119], v228 offset:2624
    v_mfma_f32_16x16x32_bf16 v[196:199], v[64:67], v[100:103], v[196:199]
    ds_read2_b32 v[88:89], v245 offset0:144 offset1:145
    s_mov_b64 exec, 0x3fff
    global_load_dword v62, v241, s[36:37]
    global_load_dword v63, v241, s[38:39]
    s_mov_b64 exec, -1
    s_waitcnt lgkmcnt(10)
    v_mfma_f32_16x16x32_bf16 v[200:203], v[72:75], v[96:99], v[200:203]
    ds_read2_b32 v[90:91], v245 offset0:146 offset1:147
    v_mfma_f32_16x16x32_bf16 v[204:207], v[72:75], v[100:103], 0
    ds_read_b128 v[120:123], v228 offset:3136
    v_mfma_f32_16x16x32_bf16 v[208:211], v[72:75], v[104:107], 0
    ds_read2_b32 v[92:93], v245 offset0:16 offset1:17
    v_mfma_f32_16x16x32_bf16 v[200:203], v[64:67], v[104:107], v[200:203]
    ds_read2_b32 v[94:95], v245 offset0:18 offset1:19
    v_mfma_f32_16x16x32_bf16 v[204:207], v[68:71], v[104:107], v[204:207]
    s_waitcnt lgkmcnt(11)
    s_nop 0
    v_mfma_f32_16x16x32_bf16 v[204:207], v[76:79], v[96:99], v[204:207]
    ds_read_b128 v[124:127], v228 offset:3648
    v_mfma_f32_16x16x32_bf16 v[208:211], v[76:79], v[100:103], v[208:211]
    ds_read2_b32 v[128:129], v242 offset0:128 offset1:129
    v_mfma_f32_16x16x32_bf16 v[212:215], v[76:79], v[104:107], 0
    ds_read2_b32 v[130:131], v242 offset0:130 offset1:131
    v_mfma_f32_16x16x32_bf16 v[216:219], v[76:79], v[108:111], 0
    v_mfma_f32_16x16x32_bf16 v[204:207], v[64:67], v[108:111], v[204:207]
    v_mfma_f32_16x16x32_bf16 v[208:211], v[68:71], v[108:111], v[208:211]
    v_mfma_f32_16x16x32_bf16 v[212:215], v[72:75], v[108:111], v[212:215]
    s_waitcnt lgkmcnt(11)
    s_nop 0
    v_mfma_f32_16x16x32_bf16 v[208:211], v[80:83], v[96:99], v[208:211]
    ds_read_b128 v[160:163], v228 offset:0
    v_mfma_f32_16x16x32_bf16 v[212:215], v[80:83], v[100:103], v[212:215]
    ds_read2_b32 v[132:133], v242 offset0:0 offset1:1
    v_mfma_f32_16x16x32_bf16 v[216:219], v[80:83], v[104:107], v[216:219]
    ds_read2_b32 v[134:135], v242 offset0:2 offset1:3
    v_mfma_f32_16x16x32_bf16 v[220:223], v[80:83], v[108:111], 0
    v_mfma_f32_16x16x32_bf16 v[208:211], v[64:67], v[112:115], v[208:211]
    v_mfma_f32_16x16x32_bf16 v[212:215], v[68:71], v[112:115], v[212:215]
    v_mfma_f32_16x16x32_bf16 v[216:219], v[72:75], v[112:115], v[216:219]
    v_mfma_f32_16x16x32_bf16 v[220:223], v[76:79], v[112:115], v[220:223]
    s_cmp_eq_u32 s49, 0
    s_cbranch_scc1 L_k1_nob6
    s_barrier
L_k1_nob6:
    s_waitcnt lgkmcnt(11)
    v_mfma_f32_16x16x32_bf16 v[212:215], v[84:87], v[96:99], v[212:215]
    ds_read_b128 v[164:167], v228 offset:512
    v_mfma_f32_16x16x32_bf16 v[216:219], v[84:87], v[100:103], v[216:219]
    ds_read2_b32 v[136:137], v243 offset0:128 offset1:129
    v_mfma_f32_16x16x32_bf16 v[220:223], v[84:87], v[104:107], v[220:223]
    ds_read2_b32 v[138:139], v243 offset0:130 offset1:131
    v_mfma_f32_16x16x32_bf16 v[212:215], v[64:67], v[116:119], v[212:215]
    v_mfma_f32_16x16x32_bf16 v[216:219], v[68:71], v[116:119], v[216:219]
    v_mfma_f32_16x16x32_bf16 v[220:223], v[72:75], v[116:119], v[220:223]
    s_waitcnt lgkmcnt(11)
    s_nop 0
    v_mfma_f32_16x16x32_bf16 v[216:219], v[88:91], v[96:99], v[216:219]
    ds_read_b128 v[168:171], v228 offset:1024
    v_mfma_f32_16x16x32_bf16 v[220:223], v[88:91], v[100:103], v[220:223]
    ds_read2_b32 v[140:141], v243 offset0:0 offset1:1
    v_mfma_f32_16x16x32_bf16 v[216:219], v[64:67], v[120:123], v[216:219]
    ds_read2_b32 v[142:143], v243 offset0:2 offset1:3
    v_mfma_f32_16x16x32_bf16 v[220:223], v[68:71], v[120:123], v[220:223]
    s_waitcnt lgkmcnt(11)
    v_mfma_f32_16x16x32_bf16 v[220:223], v[92:95], v[96:99], v[220:223]
    ds_read_b128 v[172:175], v228 offset:1536
    v_mfma_f32_16x16x32_bf16 v[220:223], v[64:67], v[124:127], v[220:223]
    ds_read2_b32 v[144:145], v244 offset0:128 offset1:129
    s_waitcnt lgkmcnt(10)
    v_mfma_f32_16x16x32_bf16 v[192:195], v[128:131], v[160:163], v[192:195]
    ds_read2_b32 v[146:147], v244 offset0:130 offset1:131
    s_waitcnt lgkmcnt(8)
    s_nop 0
    v_mfma_f32_16x16x32_bf16 v[196:199], v[132:135], v[160:163], v[196:199]
    ds_read_b128 v[176:179], v228 offset:2048
    v_mfma_f32_16x16x32_bf16 v[200:203], v[132:135], v[164:167], v[200:203]
    ds_read2_b32 v[148:149], v244 offset0:0 offset1:1
    v_mfma_f32_16x16x32_bf16 v[196:199], v[128:131], v[164:167], v[196:199]
    ds_read2_b32 v[150:151], v244 offset0:2 offset1:3
    ds_write_b128 v233, v[192:195] offset:0
    s_waitcnt lgkmcnt(9)
    s_nop 0
    v_mfma_f32_16x16x32_bf16 v[200:203], v[136:139], v[160:163], v[200:203]
    ds_read_b128 v[180:183], v228 offset:2560
    v_mfma_f32_16x16x32_bf16 v[204:207], v[136:139], v[164:167], v[204:207]
    ds_read2_b32 v[152:153], v245 offset0:128 offset1:129
    v_mfma_f32_16x16x32_bf16 v[208:211], v[136:139], v[168:171], v[208:211]
    ds_read2_b32 v[154:155], v245 offset0:130 offset1:131
    v_mfma_f32_16x16x32_bf16 v[200:203], v[128:131], v[168:171], v[200:203]
    ds_read_b128 v[184:187], v228 offset:3072
    v_mfma_f32_16x16x32_bf16 v[204:207], v[132:135], v[168:171], v[204:207]
    ds_read2_b32 v[156:157], v245 offset0:0 offset1:1
    ds_write_b128 v233, v[196:199] offset:1024
    s_waitcnt lgkmcnt(12)
    s_nop 0
    v_mfma_f32_16x16x32_bf16 v[204:207], v[140:143], v[160:163], v[204:207]
    ds_read2_b32 v[158:159], v245 offset0:2 offset1:3
    v_mfma_f32_16x16x32_bf16 v[208:211], v[140:143], v[164:167], v[208:211]
    ds_read_b128 v[188:191], v228 offset:3584
    v_mfma_f32_16x16x32_bf16 v[212:215], v[140:143], v[168:171], v[212:215]
    ds_read_b64 v[44:45], v235
    v_mfma_f32_16x16x32_bf16 v[216:219], v[140:143], v[172:175], v[216:219]
    ds_read_b64 v[46:47], v235 offset:512
    v_mfma_f32_16x16x32_bf16 v[204:207], v[128:131], v[172:175], v[204:207]
    v_mfma_f32_16x16x32_bf16 v[208:211], v[132:135], v[172:175], v[208:211]
    v_mfma_f32_16x16x32_bf16 v[212:215], v[136:139], v[172:175], v[212:215]
    ds_write_b128 v233, v[200:203] offset:2048
    s_waitcnt lgkmcnt(14)
    s_nop 0
    v_mfma_f32_16x16x32_bf16 v[208:211], v[144:147], v[160:163], v[208:211]
    ds_read_b64 v[48:49], v236
    v_mfma_f32_16x16x32_bf16 v[212:215], v[144:147], v[164:167], v[212:215]
    ds_read_b64 v[50:51], v236 offset:512
    v_mfma_f32_16x16x32_bf16 v[216:219], v[144:147], v[168:171], v[216:219]
    v_mfma_f32_16x16x32_bf16 v[220:223], v[144:147], v[172:175], v[220:223]
    v_mfma_f32_16x16x32_bf16 v[208:211], v[128:131], v[176:179], v[208:211]
    v_mfma_f32_16x16x32_bf16 v[212:215], v[132:135], v[176:179], v[212:215]
    v_mfma_f32_16x16x32_bf16 v[216:219], v[136:139], v[176:179], v[216:219]
    v_mfma_f32_16x16x32_bf16 v[220:223], v[140:143], v[176:179], v[220:223]
    ds_write_b128 v233, v[204:207] offset:3072
    s_waitcnt lgkmcnt(13)
    s_nop 0
    v_mfma_f32_16x16x32_bf16 v[212:215], v[148:151], v[160:163], v[212:215]
    v_mfma_f32_16x16x32_bf16 v[216:219], v[148:151], v[164:167], v[216:219]
    v_mfma_f32_16x16x32_bf16 v[220:223], v[148:151], v[168:171], v[220:223]
    v_mfma_f32_16x16x32_bf16 v[212:215], v[128:131], v[180:183], v[212:215]
    v_mfma_f32_16x16x32_bf16 v[216:219], v[132:135], v[180:183], v[216:219]
    v_mfma_f32_16x16x32_bf16 v[220:223], v[136:139], v[180:183], v[220:223]
    ds_write_b128 v233, v[208:211] offset:4096
    s_waitcnt lgkmcnt(11)
    v_mfma_f32_16x16x32_bf16 v[216:219], v[152:155], v[160:163], v[216:219]
    v_mfma_f32_16x16x32_bf16 v[220:223], v[152:155], v[164:167], v[220:223]
    v_mfma_f32_16x16x32_bf16 v[216:219], v[128:131], v[184:187], v[216:219]
    v_mfma_f32_16x16x32_bf16 v[220:223], v[132:135], v[184:187], v[220:223]
    ds_write_b128 v233, v[212:215] offset:5120
    s_waitcnt lgkmcnt(8)
    v_mfma_f32_16x16x32_bf16 v[220:223], v[156:159], v[160:163], v[220:223]
    v_mfma_f32_16x16x32_bf16 v[220:223], v[128:131], v[188:191], v[220:223]
    s_nop 2
    ds_write_b128 v233, v[216:219] offset:6144
    s_waitcnt lgkmcnt(4)
    v_lshlrev_b32_e64 v112, 16, v44
    v_and_b32 v113, 0xffff0000, v44
    v_lshlrev_b32_e64 v120, 16, v48
    v_and_b32 v121, 0xffff0000, v48
    v_lshlrev_b32_e64 v114, 16, v45
    v_and_b32 v115, 0xffff0000, v45
    v_lshlrev_b32_e64 v122, 16, v49
    v_and_b32 v123, 0xffff0000, v49
    v_lshlrev_b32_e64 v116, 16, v46
    v_and_b32 v117, 0xffff0000, v46
    v_lshlrev_b32_e64 v124, 16, v50
    v_and_b32 v125, 0xffff0000, v50
    v_lshlrev_b32_e64 v118, 16, v47
    v_and_b32 v119, 0xffff0000, v47
    v_lshlrev_b32_e64 v126, 16, v51
    v_and_b32 v127, 0xffff0000, v51
    ds_write_b128 v233, v[220:223] offset:7168
    v_mul_f32 v112, s58, v112
    v_mul_f32 v113, s58, v113
    v_mul_f32 v114, s58, v114
    v_mul_f32 v115, s58, v115
    v_mul_f32 v116, s58, v116
    v_mul_f32 v117, s58, v117
    v_mul_f32 v118, s58, v118
    v_mul_f32 v119, s58, v119
    v_cvt_pk_bf16_f32 v44, v112, v113
    v_cvt_pk_bf16_f32 v45, v114, v115
    v_cvt_pk_bf16_f32 v46, v116, v117
    v_cvt_pk_bf16_f32 v47, v118, v119
    v_lshlrev_b32_e64 v112, 16, v44
    v_and_b32 v113, 0xffff0000, v44
    v_lshlrev_b32_e64 v114, 16, v45
    v_and_b32 v115, 0xffff0000, v45
    v_lshlrev_b32_e64 v116, 16, v46
    v_and_b32 v117, 0xffff0000, v46
    v_lshlrev_b32_e64 v118, 16, v47
    v_and_b32 v119, 0xffff0000, v47
    s_waitcnt lgkmcnt(0) vmcnt(2)
    s_barrier
    ds_read_b128 v[64:67], v234 offset:0
    ds_read_b128 v[68:71], v234 offset:8192
    ds_read_b128 v[72:75], v234 offset:16384
    ds_read_b128 v[76:79], v234 offset:24576
    ds_read_b128 v[80:83], v234 offset:1024
    ds_read_b128 v[84:87], v234 offset:9216
    ds_read_b128 v[88:91], v234 offset:17408
    ds_read_b128 v[92:95], v234 offset:25600
    s_or_b32 s63, s2, s48
    s_cmp_lg_u32 s63, 0
    s_cbranch_scc1 L_k1_nobump
    v_mov_b32 v100, 0
    v_mov_b32_e64 v101, s53
    global_store_dword v100, v101, s[46:47] offset:0 sc1
L_k1_nobump:
    s_waitcnt lgkmcnt(0)
    s_nop 0
    v_pk_add_f32 v[64:65], v[64:65], v[68:69]
    v_pk_add_f32 v[66:67], v[66:67], v[70:71]
    v_pk_add_f32 v[80:81], v[80:81], v[84:85]
    v_pk_add_f32 v[82:83], v[82:83], v[86:87]
    v_pk_add_f32 v[72:73], v[72:73], v[76:77]
    v_pk_add_f32 v[74:75], v[74:75], v[78:79]
    v_pk_add_f32 v[88:89], v[88:89], v[92:93]
    v_pk_add_f32 v[90:91], v[90:91], v[94:95]
    v_pk_add_f32 v[64:65], v[64:65], v[72:73]
    v_pk_add_f32 v[66:67], v[66:67], v[74:75]
    v_pk_add_f32 v[80:81], v[80:81], v[88:89]
    v_pk_add_f32 v[82:83], v[82:83], v[90:91]
    v_cvt_pk_bf16_f32 v100, v64, v65
    v_cvt_pk_bf16_f32 v101, v66, v67
    v_cvt_pk_bf16_f32 v102, v80, v81
    v_cvt_pk_bf16_f32 v103, v82, v83
    v_lshlrev_b32_e64 v104, 16, v100
    v_and_b32 v105, 0xffff0000, v100
    v_lshlrev_b32_e64 v106, 16, v101
    v_and_b32 v107, 0xffff0000, v101
    v_lshlrev_b32_e64 v108, 16, v102
    v_and_b32 v109, 0xffff0000, v102
    v_lshlrev_b32_e64 v110, 16, v103
    v_and_b32 v111, 0xffff0000, v103
    v_pk_add_f32 v[104:105], v[104:105], v[112:113]
    v_pk_add_f32 v[106:107], v[106:107], v[114:115]
    v_pk_add_f32 v[108:109], v[108:109], v[116:117]
    v_pk_add_f32 v[110:111], v[110:111], v[118:119]
    v_cvt_pk_bf16_f32 v100, v104, v105
    v_cvt_pk_bf16_f32 v101, v106, v107
    v_cvt_pk_bf16_f32 v102, v108, v109
    v_cvt_pk_bf16_f32 v103, v110, v111
    v_lshlrev_b32_e64 v104, 16, v100
    v_and_b32 v105, 0xffff0000, v100
    v_lshlrev_b32_e64 v106, 16, v101
    v_and_b32 v107, 0xffff0000, v101
    v_lshlrev_b32_e64 v108, 16, v102
    v_and_b32 v109, 0xffff0000, v102
    v_lshlrev_b32_e64 v110, 16, v103
    v_and_b32 v111, 0xffff0000, v103
    v_pk_add_f32 v[104:105], v[104:105], v[120:121]
    v_pk_add_f32 v[106:107], v[106:107], v[122:123]
    v_pk_add_f32 v[108:109], v[108:109], v[124:125]
    v_pk_add_f32 v[110:111], v[110:111], v[126:127]
    v_cvt_pk_bf16_f32 v100, v104, v105
    v_cvt_pk_bf16_f32 v101, v106, v107
    v_cvt_pk_bf16_f32 v102, v108, v109
    v_cvt_pk_bf16_f32 v103, v110, v111
    global_store_dwordx2 v237, v[100:101], s[46:47] sc1
    global_store_dwordx2 v237, v[102:103], s[46:47] offset:512 sc1
    s_cmp_eq_u32 s49, 0
    s_cbranch_scc0 L_k1_fin
    s_barrier
    ds_read_b64_tr_b16 v[52:53], v239
    ds_read_b64_tr_b16 v[54:55], v239 offset:3584
    ds_read_b64_tr_b16 v[56:57], v239 offset:96
    ds_read_b64_tr_b16 v[58:59], v239 offset:3680
    v_add_u32 v60, 172032, v240
    s_waitcnt lgkmcnt(2)
    global_store_dwordx4 v240, v[52:55], s[46:47] sc1
    s_waitcnt lgkmcnt(0)
    global_store_dwordx4 v60, v[56:59], s[46:47] sc1
L_k1_fin:
    s_endpgm
L_k1_aux:
    s_waitcnt vmcnt(2)
    s_and_b32 s54, s2, 7
    s_lshl_b32 s51, s54, 2
    s_add_u32 s51, s51, s55
    s_sub_u32 s51, s51, 28
    v_mul_u32_u24 v6, 1171, v0
    v_lshrrev_b32 v6, 16, v6
    v_mul_u32_u24 v7, 56, v6
    v_sub_u32 v7, v0, v7
    v_min_u32 v6, 7, v6
    v_cmp_lt_u32 vcc, 27, v7
    v_subrev_u32 v8, 28, v7
    s_nop 0
    v_cndmask_b32 v8, v7, v8, vcc
    v_mov_b32 v10, s36
    v_mov_b32 v11, s37
    v_mov_b32 v12, s38
    v_mov_b32 v13, s39
    v_cndmask_b32 v10, v10, v12, vcc
    v_cndmask_b32 v11, v11, v13, vcc
    s_and_b32 s54, s51, 3
    s_mul_i32 s55, s54, 401408
    s_lshr_b32 s56, s51, 2
    s_mul_i32 s66, s56, 448
    s_add_u32 s55, s55, s66
    v_mul_u32_u24 v9, 50176, v6
    v_lshl_add_u32 v9, v8, 4, v9
    v_add_u32_e64 v9, s55, v9
    v_add_co_u32 v10, vcc, v10, v9
    s_nop 1
    v_addc_co_u32 v11, vcc, 0, v11, vcc
    s_barrier
    global_load_dwordx4 v[104:107], v[10:11], off
    v_add_co_u32 v10, vcc, 3584, v10
    s_nop 1
    v_addc_co_u32 v11, vcc, 0, v11, vcc
    global_load_dwordx4 v[108:111], v[10:11], off
    v_add_co_u32 v10, vcc, 3584, v10
    s_nop 1
    v_addc_co_u32 v11, vcc, 0, v11, vcc
    global_load_dwordx4 v[112:115], v[10:11], off
    v_add_co_u32 v10, vcc, 3584, v10
    s_nop 1
    v_addc_co_u32 v11, vcc, 0, v11, vcc
    global_load_dwordx4 v[116:119], v[10:11], off
    v_add_co_u32 v10, vcc, 3584, v10
    s_nop 1
    v_addc_co_u32 v11, vcc, 0, v11, vcc
    global_load_dwordx4 v[120:123], v[10:11], off
    v_add_co_u32 v10, vcc, 3584, v10
    s_nop 1
    v_addc_co_u32 v11, vcc, 0, v11, vcc
    global_load_dwordx4 v[124:127], v[10:11], off
    v_add_co_u32 v10, vcc, 3584, v10
    s_nop 1
    v_addc_co_u32 v11, vcc, 0, v11, vcc
    global_load_dwordx4 v[128:131], v[10:11], off
    v_add_co_u32 v10, vcc, 3584, v10
    s_nop 1
    v_addc_co_u32 v11, vcc, 0, v11, vcc
    global_load_dwordx4 v[132:135], v[10:11], off
    v_add_co_u32 v10, vcc, 3584, v10
    s_nop 1
    v_addc_co_u32 v11, vcc, 0, v11, vcc
    global_load_dwordx4 v[136:139], v[10:11], off
    v_add_co_u32 v10, vcc, 3584, v10
    s_nop 1
    v_addc_co_u32 v11, vcc, 0, v11, vcc
    global_load_dwordx4 v[140:143], v[10:11], off
    v_add_co_u32 v10, vcc, 3584, v10
    s_nop 1
    v_addc_co_u32 v11, vcc, 0, v11, vcc
    global_load_dwordx4 v[144:147], v[10:11], off
    v_add_co_u32 v10, vcc, 3584, v10
    s_nop 1
    v_addc_co_u32 v11, vcc, 0, v11, vcc
    global_load_dwordx4 v[148:151], v[10:11], off
    v_add_co_u32 v10, vcc, 3584, v10
    s_nop 1
    v_addc_co_u32 v11, vcc, 0, v11, vcc
    global_load_dwordx4 v[152:155], v[10:11], off
    v_add_co_u32 v10, vcc, 3584, v10
    s_nop 1
    v_addc_co_u32 v11, vcc, 0, v11, vcc
    global_load_dwordx4 v[156:159], v[10:11], off
    s_getpc_b64 s[60:61]
L_k1_pc1:
    s_add_u32 s60, s60, k1_code_end-L_k1_pc1
    s_addc_u32 s61, s61, 0
    v_lshlrev_b32 v1, 7, v0
    v_min_u32 v1, all_code_end-k1_code_end-4, v1
    global_load_dword v100, v1, s[60:61]
    s_waitcnt vmcnt(14)
    v_lshlrev_b32 v16, 16, v104
    v_and_b32 v17, 0xffff0000, v104
    v_lshlrev_b32_e64 v18, 16, v105
    v_and_b32 v19, 0xffff0000, v105
    v_lshlrev_b32_e64 v20, 16, v106
    v_and_b32 v21, 0xffff0000, v106
    v_lshlrev_b32_e64 v22, 16, v107
    v_and_b32 v23, 0xffff0000, v107
    s_waitcnt vmcnt(13)
    v_lshlrev_b32 v24, 16, v108
    v_and_b32 v25, 0xffff0000, v108
    v_pk_add_f32 v[16:17], v[16:17], v[24:25]
    v_lshlrev_b32_e64 v26, 16, v109
    v_and_b32 v27, 0xffff0000, v109
    v_pk_add_f32 v[18:19], v[18:19], v[26:27]
    v_lshlrev_b32_e64 v28, 16, v110
    v_and_b32 v29, 0xffff0000, v110
    v_pk_add_f32 v[20:21], v[20:21], v[28:29]
    v_lshlrev_b32_e64 v30, 16, v111
    v_and_b32 v31, 0xffff0000, v111
    v_pk_add_f32 v[22:23], v[22:23], v[30:31]
    s_waitcnt vmcnt(12)
    v_lshlrev_b32 v24, 16, v112
    v_and_b32 v25, 0xffff0000, v112
    v_pk_add_f32 v[16:17], v[16:17], v[24:25]
    v_lshlrev_b32_e64 v26, 16, v113
    v_and_b32 v27, 0xffff0000, v113
    v_pk_add_f32 v[18:19], v[18:19], v[26:27]
    v_lshlrev_b32_e64 v28, 16, v114
    v_and_b32 v29, 0xffff0000, v114
    v_pk_add_f32 v[20:21], v[20:21], v[28:29]
    v_lshlrev_b32_e64 v30, 16, v115
    v_and_b32 v31, 0xffff0000, v115
    v_pk_add_f32 v[22:23], v[22:23], v[30:31]
    s_waitcnt vmcnt(11)
    v_lshlrev_b32 v24, 16, v116
    v_and_b32 v25, 0xffff0000, v116
    v_pk_add_f32 v[16:17], v[16:17], v[24:25]
    v_lshlrev_b32_e64 v26, 16, v117
    v_and_b32 v27, 0xffff0000, v117
    v_pk_add_f32 v[18:19], v[18:19], v[26:27]
    v_lshlrev_b32_e64 v28, 16, v118
    v_and_b32 v29, 0xffff0000, v118
    v_pk_add_f32 v[20:21], v[20:21], v[28:29]
    v_lshlrev_b32_e64 v30, 16, v119
    v_and_b32 v31, 0xffff0000, v119
    v_pk_add_f32 v[22:23], v[22:23], v[30:31]
    s_waitcnt vmcnt(10)
    v_lshlrev_b32 v24, 16, v120
    v_and_b32 v25, 0xffff0000, v120
    v_pk_add_f32 v[16:17], v[16:17], v[24:25]
    v_lshlrev_b32_e64 v26, 16, v121
    v_and_b32 v27, 0xffff0000, v121
    v_pk_add_f32 v[18:19], v[18:19], v[26:27]
    v_lshlrev_b32_e64 v28, 16, v122
    v_and_b32 v29, 0xffff0000, v122
    v_pk_add_f32 v[20:21], v[20:21], v[28:29]
    v_lshlrev_b32_e64 v30, 16, v123
    v_and_b32 v31, 0xffff0000, v123
    v_pk_add_f32 v[22:23], v[22:23], v[30:31]
    s_waitcnt vmcnt(9)
    v_lshlrev_b32 v24, 16, v124
    v_and_b32 v25, 0xffff0000, v124
    v_pk_add_f32 v[16:17], v[16:17], v[24:25]
    v_lshlrev_b32_e64 v26, 16, v125
    v_and_b32 v27, 0xffff0000, v125
    v_pk_add_f32 v[18:19], v[18:19], v[26:27]
    v_lshlrev_b32_e64 v28, 16, v126
    v_and_b32 v29, 0xffff0000, v126
    v_pk_add_f32 v[20:21], v[20:21], v[28:29]
    v_lshlrev_b32_e64 v30, 16, v127
    v_and_b32 v31, 0xffff0000, v127
    v_pk_add_f32 v[22:23], v[22:23], v[30:31]
    s_waitcnt vmcnt(8)
    v_lshlrev_b32 v24, 16, v128
    v_and_b32 v25, 0xffff0000, v128
    v_pk_add_f32 v[16:17], v[16:17], v[24:25]
    v_lshlrev_b32_e64 v26, 16, v129
    v_and_b32 v27, 0xffff0000, v129
    v_pk_add_f32 v[18:19], v[18:19], v[26:27]
    v_lshlrev_b32_e64 v28, 16, v130
    v_and_b32 v29, 0xffff0000, v130
    v_pk_add_f32 v[20:21], v[20:21], v[28:29]
    v_lshlrev_b32_e64 v30, 16, v131
    v_and_b32 v31, 0xffff0000, v131
    v_pk_add_f32 v[22:23], v[22:23], v[30:31]
    s_waitcnt vmcnt(7)
    v_lshlrev_b32 v24, 16, v132
    v_and_b32 v25, 0xffff0000, v132
    v_pk_add_f32 v[16:17], v[16:17], v[24:25]
    v_lshlrev_b32_e64 v26, 16, v133
    v_and_b32 v27, 0xffff0000, v133
    v_pk_add_f32 v[18:19], v[18:19], v[26:27]
    v_lshlrev_b32_e64 v28, 16, v134
    v_and_b32 v29, 0xffff0000, v134
    v_pk_add_f32 v[20:21], v[20:21], v[28:29]
    v_lshlrev_b32_e64 v30, 16, v135
    v_and_b32 v31, 0xffff0000, v135
    v_pk_add_f32 v[22:23], v[22:23], v[30:31]
    s_waitcnt vmcnt(6)
    v_lshlrev_b32 v24, 16, v136
    v_and_b32 v25, 0xffff0000, v136
    v_pk_add_f32 v[16:17], v[16:17], v[24:25]
    v_lshlrev_b32_e64 v26, 16, v137
    v_and_b32 v27, 0xffff0000, v137
    v_pk_add_f32 v[18:19], v[18:19], v[26:27]
    v_lshlrev_b32_e64 v28, 16, v138
    v_and_b32 v29, 0xffff0000, v138
    v_pk_add_f32 v[20:21], v[20:21], v[28:29]
    v_lshlrev_b32_e64 v30, 16, v139
    v_and_b32 v31, 0xffff0000, v139
    v_pk_add_f32 v[22:23], v[22:23], v[30:31]
    s_waitcnt vmcnt(5)
    v_lshlrev_b32 v24, 16, v140
    v_and_b32 v25, 0xffff0000, v140
    v_pk_add_f32 v[16:17], v[16:17], v[24:25]
    v_lshlrev_b32_e64 v26, 16, v141
    v_and_b32 v27, 0xffff0000, v141
    v_pk_add_f32 v[18:19], v[18:19], v[26:27]
    v_lshlrev_b32_e64 v28, 16, v142
    v_and_b32 v29, 0xffff0000, v142
    v_pk_add_f32 v[20:21], v[20:21], v[28:29]
    v_lshlrev_b32_e64 v30, 16, v143
    v_and_b32 v31, 0xffff0000, v143
    v_pk_add_f32 v[22:23], v[22:23], v[30:31]
    s_waitcnt vmcnt(4)
    v_lshlrev_b32 v24, 16, v144
    v_and_b32 v25, 0xffff0000, v144
    v_pk_add_f32 v[16:17], v[16:17], v[24:25]
    v_lshlrev_b32_e64 v26, 16, v145
    v_and_b32 v27, 0xffff0000, v145
    v_pk_add_f32 v[18:19], v[18:19], v[26:27]
    v_lshlrev_b32_e64 v28, 16, v146
    v_and_b32 v29, 0xffff0000, v146
    v_pk_add_f32 v[20:21], v[20:21], v[28:29]
    v_lshlrev_b32_e64 v30, 16, v147
    v_and_b32 v31, 0xffff0000, v147
    v_pk_add_f32 v[22:23], v[22:23], v[30:31]
    s_waitcnt vmcnt(3)
    v_lshlrev_b32 v24, 16, v148
    v_and_b32 v25, 0xffff0000, v148
    v_pk_add_f32 v[16:17], v[16:17], v[24:25]
    v_lshlrev_b32_e64 v26, 16, v149
    v_and_b32 v27, 0xffff0000, v149
    v_pk_add_f32 v[18:19], v[18:19], v[26:27]
    v_lshlrev_b32_e64 v28, 16, v150
    v_and_b32 v29, 0xffff0000, v150
    v_pk_add_f32 v[20:21], v[20:21], v[28:29]
    v_lshlrev_b32_e64 v30, 16, v151
    v_and_b32 v31, 0xffff0000, v151
    v_pk_add_f32 v[22:23], v[22:23], v[30:31]
    s_waitcnt vmcnt(2)
    v_lshlrev_b32 v24, 16, v152
    v_and_b32 v25, 0xffff0000, v152
    v_pk_add_f32 v[16:17], v[16:17], v[24:25]
    v_lshlrev_b32_e64 v26, 16, v153
    v_and_b32 v27, 0xffff0000, v153
    v_pk_add_f32 v[18:19], v[18:19], v[26:27]
    v_lshlrev_b32_e64 v28, 16, v154
    v_and_b32 v29, 0xffff0000, v154
    v_pk_add_f32 v[20:21], v[20:21], v[28:29]
    v_lshlrev_b32_e64 v30, 16, v155
    v_and_b32 v31, 0xffff0000, v155
    v_pk_add_f32 v[22:23], v[22:23], v[30:31]
    s_waitcnt vmcnt(1)
    v_lshlrev_b32 v24, 16, v156
    v_and_b32 v25, 0xffff0000, v156
    v_pk_add_f32 v[16:17], v[16:17], v[24:25]
    v_lshlrev_b32_e64 v26, 16, v157
    v_and_b32 v27, 0xffff0000, v157
    v_pk_add_f32 v[18:19], v[18:19], v[26:27]
    v_lshlrev_b32_e64 v28, 16, v158
    v_and_b32 v29, 0xffff0000, v158
    v_pk_add_f32 v[20:21], v[20:21], v[28:29]
    v_lshlrev_b32_e64 v30, 16, v159
    v_and_b32 v31, 0xffff0000, v159
    v_pk_add_f32 v[22:23], v[22:23], v[30:31]
    v_lshlrev_b32_e64 v7, 5, v0
    v_add_u32 v7, 57344, v7
    ds_write_b128 v7, v[16:19]
    ds_write_b128 v7, v[20:23] offset:16
    s_waitcnt vmcnt(0) lgkmcnt(0)
    s_barrier
    v_lshlrev_b32_e64 v103, 2, v0
    v_add_u32 v7, 57344, v103
    ds_read_b32 v48, v7 offset:0
    ds_read_b32 v49, v7 offset:1792
    ds_read_b32 v50, v7 offset:3584
    ds_read_b32 v51, v7 offset:5376
    ds_read_b32 v52, v7 offset:7168
    ds_read_b32 v53, v7 offset:8960
    ds_read_b32 v54, v7 offset:10752
    ds_read_b32 v55, v7 offset:12544
    v_cmp_lt_u32 vcc, 223, v0
    v_mov_b32 v14, 6272
    s_nop 0
    v_cndmask_b32 v14, 0, v14, vcc
    s_mul_i32 s68, s54, 14336
    s_mul_i32 s69, s56, 896
    s_add_u32 s68, s68, s69
    s_add_u32 s68, s68, 11534336
    v_add3_u32 v103, v103, v14, s68
    s_waitcnt lgkmcnt(0)
    v_pk_add_f32 v[48:49], v[48:49], v[50:51]
    v_pk_add_f32 v[48:49], v[48:49], v[52:53]
    v_pk_add_f32 v[48:49], v[48:49], v[54:55]
    v_add_f32_e64 v8, v48, v49
    s_cmp_ge_u32 s48, 7
    s_cbranch_scc1 L_k1_nocs
    global_store_dword v103, v8, s[46:47] sc1
L_k1_nocs:
L_k1_auxdone:
L_k1_kernel_exit:
    s_endpgm
.p2align 7
.type k1_gtab,@object
k1_gtab:
.short 3900, 3900, 3900, 3900, 3896, 3896, 3896, 3896
.short 3896, 3896, 3896, 3892, 3892, 3892, 3892, 3892
.short 3892, 3892, 3892, 3892, 3888, 3888, 3888, 3888
.short 3888, 3888, 3888, 3884, 3884, 3884, 3884, 3884
.short 3884, 3884, 3884, 3884, 3880, 3880, 3880, 3880
.short 3880, 3880, 3880, 3876, 3876, 3876, 3876, 3876
.short 3876, 3876, 3876, 3876, 3872, 3872, 3872, 3872
.short 3872, 3872, 3872, 3868, 3868, 3868, 3868, 3868
.short 3868, 3868, 3868, 3868, 3864, 3864, 3864, 3864
.short 3864, 3864, 3864, 3860, 3860, 3860, 3860, 3860
.short 3860, 3860, 3860, 3860, 3856, 3856, 3856, 3856
.short 3856, 3856, 3856, 3852, 3852, 3852, 3852, 3852
.short 3852, 3852, 3852, 3852, 3848, 3848, 3848, 3848
.short 3848, 3848, 3848, 3844, 3844, 3844, 3844, 3844
.short 3844, 3844, 3844, 3844, 3840, 3840, 3840, 3840
.short 3840, 3840, 3840, 2876, 2876, 2876, 2876, 2876
.short 2876, 2876, 2876, 2876, 2872, 2872, 2872, 2872
.short 2872, 2872, 2872, 2868, 2868, 2868, 2868, 2868
.short 2868, 2868, 2868, 2868, 2864, 2864, 2864, 2864
.short 2864, 2864, 2864, 2860, 2860, 2860, 2860, 2860
.short 2860, 2860, 2860, 2860, 2856, 2856, 2856, 2856
.short 2856, 2856, 2856, 2852, 2852, 2852, 2852, 2852
.short 2852, 2852, 2852, 2852, 2848, 2848, 2848, 2848
.short 2848, 2848, 2848, 2844, 2844, 2844, 2844, 2844
.short 2844, 2844, 2844, 2844, 2840, 2840, 2840, 2840
.short 2840, 2840, 2840, 2836, 2836, 2836, 2836, 2836
.short 2836, 2836, 2836, 2836, 2832, 2832, 2832, 2832
.short 2832, 2832, 2832, 2828, 2828, 2828, 2828, 2828
.short 2828, 2828, 2828, 2828, 2824, 2824, 2824, 2824
.short 2824, 2824, 2824, 2820, 2820, 2820, 2820, 2820
.short 2820, 2820, 2820, 2820, 2816, 2816, 2816, 2816
.short 2816, 2816, 2816, 3644, 3644, 3644, 3644, 3644
.short 3644, 3644, 3644, 3644, 3640, 3640, 3640, 3640
.short 3640, 3640, 3640, 3636, 3636, 3636, 3636, 3636
.short 3636, 3636, 3636, 3636, 3632, 3632, 3632, 3632
.short 3632, 3632, 3632, 3628, 3628, 3628, 3628, 3628
.short 3628, 3628, 3628, 3628, 3624, 3624, 3624, 3624
.short 3624, 3624, 3624, 3620, 3620, 3620, 3620, 3620
.short 3620, 3620, 3620, 3620, 3616, 3616, 3616, 3616
.short 3616, 3616, 3616, 3612, 3612, 3612, 3612, 3612
.short 3612, 3612, 3612, 3612, 3608, 3608, 3608, 3608
.short 3608, 3608, 3608, 3604, 3604, 3604, 3604, 3604
.short 3604, 3604, 3604, 3604, 3600, 3600, 3600, 3600
.short 3600, 3600, 3600, 3596, 3596, 3596, 3596, 3596
.short 3596, 3596, 3596, 3596, 3592, 3592, 3592, 3592
.short 3592, 3592, 3592, 3588, 3588, 3588, 3588, 3588
.short 3588, 3588, 3588, 3588, 3584, 3584, 3584, 3584
.short 3584, 3584, 3584, 2620, 2620, 2620, 2620, 2620
.short 2620, 2620, 2620, 2620, 2616, 2616, 2616, 2616
.short 2616, 2616, 2616, 2612, 2612, 2612, 2612, 2612
.short 2612, 2612, 2612, 2612, 2608, 2608, 2608, 2608
.short 2608, 2608, 2608, 2604, 2604, 2604, 2604, 2604
.short 2604, 2604, 2604, 2604, 2600, 2600, 2600, 2600
.short 2600, 2600, 2600, 2596, 2596, 2596, 2596, 2596
.short 2596, 2596, 2596, 2596, 2592, 2592, 2592, 2592
.short 2592, 2592, 2592, 2588, 2588, 2588, 2588, 2588
.short 2588, 2588, 2588, 2588, 2584, 2584, 2584, 2584
.short 2584, 2584, 2584, 2580, 2580, 2580, 2580, 2580
.short 2580, 2580, 2580, 2580, 2576, 2576, 2576, 2576
.short 2576, 2576, 2576, 2572, 2572, 2572, 2572, 2572
.short 2572, 2572, 2572, 2572, 2568, 2568, 2568, 2568
.short 2568, 2568, 2568, 2564, 2564, 2564, 2564, 2564
.short 2564, 2564, 2564, 2564, 2560, 2560, 2560, 2560
.short 2560, 2560, 2560, 3388, 3388, 3388, 3388, 3388
.short 3388, 3388, 3388, 3388, 3384, 3384, 3384, 3384
.short 3384, 3384, 3384, 3380, 3380, 3380, 3380, 3380
.short 3380, 3380, 3380, 3380, 3376, 3376, 3376, 3376
.short 3376, 3376, 3376, 3372, 3372, 3372, 3372, 3372
.short 3372, 3372, 3372, 3372, 3368, 3368, 3368, 3368
.short 3368, 3368, 3368, 3364, 3364, 3364, 3364, 3364
.short 3364, 3364, 3364, 3364, 3360, 3360, 3360, 3360
.short 3360, 3360, 3360, 3356, 3356, 3356, 3356, 3356
.short 3356, 3356, 3356, 3356, 3352, 3352, 3352, 3352
.short 3352, 3352, 3352, 3348, 3348, 3348, 3348, 3348
.short 3348, 3348, 3348, 3348, 3344, 3344, 3344, 3344
.short 3344, 3344, 3344, 3340, 3340, 3340, 3340, 3340
.short 3340, 3340, 3340, 3340, 3336, 3336, 3336, 3336
.short 3336, 3336, 3336, 3332, 3332, 3332, 3332, 3332
.short 3332, 3332, 3332, 3332, 3328, 3328, 3328, 3328
.short 3328, 3328, 3328, 2364, 2364, 2364, 2364, 2364
.short 2364, 2364, 2364, 2364, 2360, 2360, 2360, 2360
.short 2360, 2360, 2360, 2356, 2356, 2356, 2356, 2356
.short 2356, 2356, 2356, 2356, 2352, 2352, 2352, 2352
.short 2352, 2352, 2352, 2348, 2348, 2348, 2348, 2348
.short 2348, 2348, 2348, 2348, 2344, 2344, 2344, 2344
.short 2344, 2344, 2344, 2340, 2340, 2340, 2340, 2340
.short 2340, 2340, 2340, 2340, 2336, 2336, 2336, 2336
.short 2336, 2336, 2336, 2332, 2332, 2332, 2332, 2332
.short 2332, 2332, 2332, 2332, 2328, 2328, 2328, 2328
.short 2328, 2328, 2328, 2324, 2324, 2324, 2324, 2324
.short 2324, 2324, 2324, 2324, 2320, 2320, 2320, 2320
.short 2320, 2320, 2320, 2316, 2316, 2316, 2316, 2316
.short 2316, 2316, 2316, 2316, 2312, 2312, 2312, 2312
.short 2312, 2312, 2312, 2308, 2308, 2308, 2308, 2308
.short 2308, 2308, 2308, 2308, 2304, 2304, 2304, 2304
.short 2304, 2304, 2304, 3132, 3132, 3132, 3132, 3132
.short 3132, 3132, 3132, 3132, 3128, 3128, 3128, 3128
.short 3128, 3128, 3128, 3124, 3124, 3124, 3124, 3124
.short 3124, 3124, 3124, 3124, 3120, 3120, 3120, 3120
.short 3120, 3120, 3120, 3116, 3116, 3116, 3116, 3116
.short 3116, 3116, 3116, 3116, 3112, 3112, 3112, 3112
.short 3112, 3112, 3112, 3108, 3108, 3108, 3108, 3108
.short 3108, 3108, 3108, 3108, 3104, 3104, 3104, 3104
.short 3104, 3104, 3104, 3100, 3100, 3100, 3100, 3100
.short 3100, 3100, 3100, 3100, 3096, 3096, 3096, 3096
.short 3096, 3096, 3096, 3092, 3092, 3092, 3092, 3092
.short 3092, 3092, 3092, 3092, 3088, 3088, 3088, 3088
.short 3088, 3088, 3088, 3084, 3084, 3084, 3084, 3084
.short 3084, 3084, 3084, 3084, 3080, 3080, 3080, 3080
.short 3080, 3080, 3080, 3076, 3076, 3076, 3076, 3076
.short 3076, 3076, 3076, 3076, 3072, 3072, 3072, 3072
.short 3072, 3072, 3072, 2108, 2108, 2108, 2108, 2108
.short 2108, 2108, 2108, 2108, 2104, 2104, 2104, 2104
.short 2104, 2104, 2104, 2100, 2100, 2100, 2100, 2100
.short 2100, 2100, 2100, 2100, 2096, 2096, 2096, 2096
.short 2096, 2096, 2096, 2092, 2092, 2092, 2092, 2092
.short 2092, 2092, 2092, 2092, 2088, 2088, 2088, 2088
.short 2088, 2088, 2088, 2084, 2084, 2084, 2084, 2084
.short 2084, 2084, 2084, 2084, 2080, 2080, 2080, 2080
.short 2080, 2080, 2080, 2076, 2076, 2076, 2076, 2076
.short 2076, 2076, 2076, 2076, 2072, 2072, 2072, 2072
.short 2072, 2072, 2072, 2068, 2068, 2068, 2068, 2068
.short 2068, 2068, 2068, 2068, 2064, 2064, 2064, 2064
.short 2064, 2064, 2064, 2060, 2060, 2060, 2060, 2060
.short 2060, 2060, 2060, 2060, 2056, 2056, 2056, 2056
.short 2056, 2056, 2056, 2052, 2052, 2052, 2052, 2052
.short 2052, 2052, 2052, 2052, 2048, 2048, 2048, 2048
.short 2048, 2048, 2048, 2044, 2044, 2044, 2044, 2044
.short 2044, 2044, 1788, 1788, 1788, 2040, 2040, 2040
.short 2040, 2040, 1784, 1784, 1784, 2036, 2036, 2036
.short 2036, 2036, 1780, 1780, 1780, 2032, 2032, 2032
.short 2032, 2032, 1776, 1776, 1776, 2028, 2028, 2028
.short 2028, 2028, 1772, 1772, 1772, 2024, 2024, 2024
.short 2024, 2024, 1768, 1768, 1768, 2020, 2020, 2020
.short 2020, 2020, 1764, 1764, 1764, 2016, 2016, 2016
.short 2016, 2016, 1760, 1760, 1760, 2012, 2012, 2012
.short 2012, 2012, 1756, 1756, 1756, 2008, 2008, 2008
.short 2008, 2008, 1752, 1752, 1752, 2004, 2004, 2004
.short 2004, 2004, 1748, 1748, 1748, 2000, 2000, 2000
.short 2000, 2000, 1744, 1744, 1744, 1996, 1996, 1996
.short 1996, 1996, 1740, 1740, 1740, 1992, 1992, 1992
.short 1992, 1992, 1736, 1736, 1736, 1988, 1988, 1988
.short 1988, 1988, 1732, 1732, 1732, 1984, 1984, 1984
.short 1984, 1984, 1728, 1728, 1728, 1020, 1020, 1020
.short 1020, 1020, 764, 764, 764, 1016, 1016, 1016
.short 1016, 1016, 760, 760, 760, 1012, 1012, 1012
.short 1012, 1012, 756, 756, 756, 1008, 1008, 1008
.short 1008, 1008, 752, 752, 752, 1004, 1004, 1004
.short 1004, 1004, 748, 748, 748, 1000, 1000, 1000
.short 1000, 1000, 744, 744, 744, 996, 996, 996
.short 996, 996, 740, 740, 740, 992, 992, 992
.short 992, 992, 736, 736, 736, 988, 988, 988
.short 988, 988, 732, 732, 732, 984, 984, 984
.short 984, 984, 728, 728, 728, 980, 980, 980
.short 980, 980, 724, 724, 724, 976, 976, 976
.short 976, 976, 720, 720, 720, 972, 972, 972
.short 972, 972, 716, 716, 716, 968, 968, 968
.short 968, 968, 712, 712, 712, 964, 964, 964
.short 964, 964, 708, 708, 708, 960, 960, 960
.short 960, 960, 704, 704, 704, 1532, 1532, 1532
.short 1532, 1532, 1276, 1276, 1276, 1528, 1528, 1528
.short 1528, 1528, 1272, 1272, 1272, 1524, 1524, 1524
.short 1524, 1524, 1268, 1268, 1268, 1520, 1520, 1520
.short 1520, 1520, 1264, 1264, 1264, 1516, 1516, 1516
.short 1516, 1516, 1260, 1260, 1260, 1512, 1512, 1512
.short 1512, 1512, 1256, 1256, 1256, 1508, 1508, 1508
.short 1508, 1508, 1252, 1252, 1252, 1504, 1504, 1504
.short 1504, 1504, 1248, 1248, 1248, 1500, 1500, 1500
.short 1500, 1500, 1244, 1244, 1244, 1496, 1496, 1496
.short 1496, 1496, 1240, 1240, 1240, 1492, 1492, 1492
.short 1492, 1492, 1236, 1236, 1236, 1488, 1488, 1488
.short 1488, 1488, 1232, 1232, 1232, 1484, 1484, 1484
.short 1484, 1484, 1228, 1228, 1228, 1480, 1480, 1480
.short 1480, 1480, 1224, 1224, 1224, 1476, 1476, 1476
.short 1476, 1476, 1220, 1220, 1220, 1472, 1472, 1472
.short 1472, 1472, 1216, 1216, 1216, 508, 508, 508
.short 508, 508, 252, 252, 252, 504, 504, 504
.short 504, 504, 248, 248, 248, 500, 500, 500
.short 500, 500, 244, 244, 244, 496, 496, 496
.short 496, 496, 240, 240, 240, 492, 492, 492
.short 492, 492, 236, 236, 236, 488, 488, 488
.short 488, 488, 232, 232, 232, 484, 484, 484
.short 484, 484, 228, 228, 228, 480, 480, 480
.short 480, 480, 224, 224, 224, 476, 476, 476
.short 476, 476, 220, 220, 220, 472, 472, 472
.short 472, 472, 216, 216, 216, 468, 468, 468
.short 468, 468, 212, 212, 212, 464, 464, 464
.short 464, 464, 208, 208, 208, 460, 460, 460
.short 460, 460, 204, 204, 204, 456, 456, 456
.short 456, 456, 200, 200, 200, 452, 452, 452
.short 452, 452, 196, 196, 196, 448, 448, 448
.short 448, 448, 192, 192, 192, 1980, 1980, 1980
.short 1980, 1724, 1468, 1468, 1468, 1212, 1976, 1976
.short 1976, 1720, 1464, 1464, 1464, 1208, 1972, 1972
.short 1972, 1716, 1460, 1460, 1460, 1204, 1968, 1968
.short 1968, 1712, 1456, 1456, 1456, 1200, 1964, 1964
.short 1964, 1708, 1452, 1452, 1452, 1196, 1960, 1960
.short 1960, 1704, 1448, 1448, 1448, 1192, 1956, 1956
.short 1956, 1700, 1444, 1444, 1444, 1188, 1952, 1952
.short 1952, 1696, 1440, 1440, 1440, 1184, 1948, 1948
.short 1948, 1692, 1436, 1436, 1436, 1180, 1944, 1944
.short 1944, 1688, 1432, 1432, 1432, 1176, 1940, 1940
.short 1940, 1684, 1428, 1428, 1428, 1172, 1936, 1936
.short 1936, 1680, 1424, 1424, 1424, 1168, 1932, 1932
.short 1932, 1676, 1420, 1420, 1420, 1164, 1928, 1928
.short 1928, 1672, 1416, 1416, 1416, 1160, 1924, 1924
.short 1924, 1668, 1412, 1412, 1412, 1156, 1920, 1920
.short 1920, 1664, 1408, 1408, 1408, 1152, 956, 956
.short 956, 700, 444, 444, 444, 188, 952, 952
.short 952, 696, 440, 440, 440, 184, 948, 948
.short 948, 692, 436, 436, 436, 180, 944, 944
.short 944, 688, 432, 432, 432, 176, 940, 940
.short 940, 684, 428, 428, 428, 172, 936, 936
.short 936, 680, 424, 424, 424, 168, 932, 932
.short 932, 676, 420, 420, 420, 164, 928, 928
.short 928, 672, 416, 416, 416, 160, 924, 924
.short 924, 668, 412, 412, 412, 156, 920, 920
.short 920, 664, 408, 408, 408, 152, 916, 916
.short 916, 660, 404, 404, 404, 148, 912, 912
.short 912, 656, 400, 400, 400, 144, 908, 908
.short 908, 652, 396, 396, 396, 140, 904, 904
.short 904, 648, 392, 392, 392, 136, 900, 900
.short 900, 644, 388, 388, 388, 132, 896, 896
.short 896, 640, 384, 384, 384, 128, 1916, 1916
.short 1660, 1404, 1148, 1852, 1596, 1340, 1084, 1912
.short 1656, 1400, 1144, 1848, 1592, 1336, 1080, 1908
.short 1652, 1396, 1140, 1844, 1588, 1332, 1076, 1904
.short 1648, 1392, 1136, 1840, 1584, 1328, 1072, 1900
.short 1644, 1388, 1132, 1836, 1580, 1324, 1068, 1896
.short 1640, 1384, 1128, 1832, 1576, 1320, 1064, 1892
.short 1636, 1380, 1124, 1828, 1572, 1316, 1060, 1888
.short 1632, 1376, 1120, 1824, 1568, 1312, 1056, 1884
.short 1628, 1372, 1116, 1820, 1564, 1308, 1052, 1880
.short 1624, 1368, 1112, 1816, 1560, 1304, 1048, 1876
.short 1620, 1364, 1108, 1812, 1556, 1300, 1044, 1872
.short 1616, 1360, 1104, 1808, 1552, 1296, 1040, 1868
.short 1612, 1356, 1100, 1804, 1548, 1292, 1036, 1864
.short 1608, 1352, 1096, 1800, 1544, 1288, 1032, 1860
.short 1604, 1348, 1092, 1796, 1540, 1284, 1028, 1856
.short 1600, 1344, 1088, 1792, 1536, 1280, 1024, 892
.short 636, 380, 124, 828, 572, 316, 60, 888
.short 632, 376, 120, 824, 568, 312, 56, 884
.short 628, 372, 116, 820, 564, 308, 52, 880
.short 624, 368, 112, 816, 560, 304, 48, 876
.short 620, 364, 108, 812, 556, 300, 44, 872
.short 616, 360, 104, 808, 552, 296, 40, 868
.short 612, 356, 100, 804, 548, 292, 36, 864
.short 608, 352, 96, 800, 544, 288, 32, 860
.short 604, 348, 92, 796, 540, 284, 28, 856
.short 600, 344, 88, 792, 536, 280, 24, 852
.short 596, 340, 84, 788, 532, 276, 20, 848
.short 592, 336, 80, 784, 528, 272, 16, 844
.short 588, 332, 76, 780, 524, 268, 12, 840
.short 584, 328, 72, 776, 520, 264, 8, 836
.short 580, 324, 68, 772, 516, 260, 4, 832
.short 576, 320, 64, 768, 512, 256, 0, 2112
.short 4096, 4096, 4096, 4096, 4096, 4096, 4096, 4096
.skip 112
.long 0, 0, 33280, 44704, 44704, 110240, 118560, 117984, 135872, 144672, 65536, 135968, 16777216, 4096, 135968, 152864, 2097152, 110240, 152864, 0, 0, 0, 0, 0, 0, 0, 0, 0, 0, 0, 0, 0
.long 256, 16640, 33280, 52896, 46752, 111264, 119584, 117856, 135744, 145696, 66560, 136992, 17235968, 6144, 136480, 152896, 2154496, 110240, 153888, 0, 0, 0, 0, 0, 0, 0, 0, 0, 0, 0, 0, 0
.long 512, 0, 49920, 61088, 48800, 112288, 120608, 117728, 135616, 146720, 67584, 138016, 17694720, 8192, 136992, 152928, 2211840, 110240, 154912, 0, 0, 0, 0, 0, 0, 0, 0, 0, 0, 0, 0, 0
.long 768, 16640, 49920, 69280, 50848, 113312, 121632, 117600, 135488, 147744, 68608, 139040, 18153472, 10240, 137504, 152960, 2269184, 110240, 155936, 0, 0, 0, 0, 0, 0, 0, 0, 0, 0, 0, 0, 0
.long 55120, 55120, 88400, 77472, 77472, 114400, 127008, 126432, 140480, 148768, 69632, 140576, 18612224, 12288, 138016, 152864, 2097152, 114400, 152864, 0, 0, 0, 0, 0, 0, 0, 0, 0, 0, 0, 0, 0
.long 55376, 71760, 88400, 85664, 79520, 115424, 128032, 126304, 140352, 149792, 70656, 141600, 19070976, 14336, 138528, 152896, 2154496, 114400, 153888, 0, 0, 0, 0, 0, 0, 0, 0, 0, 0, 0, 0, 0
.long 55632, 55120, 105040, 93856, 81568, 116448, 129056, 126176, 140224, 150816, 71680, 142624, 19529728, 16384, 139040, 152928, 2211840, 114400, 154912, 0, 0, 0, 0, 0, 0, 0, 0, 0, 0, 0, 0, 0
.long 55888, 71760, 105040, 102048, 83616, 117472, 130080, 126048, 140096, 151840, 72704, 143648, 19988480, 18432, 139552, 152960, 2269184, 114400, 155936, 0, 0, 0, 0, 0, 0, 0, 0, 0, 0, 0, 0, 0
.size k1_gtab, 5248
k1_code_end:
.globl k2_kernel
.p2align 8
.type k2_kernel,@function
k2_kernel:
    s_cmp_ge_u32 s2, 256
    s_cbranch_scc1 L_k2_kernel_exit
    s_load_dwordx16 s[16:31], s[0:1], 0
    s_load_dwordx16 s[32:47], s[0:1], 64
    v_lshrrev_b32 v1, 6, v0
    v_and_b32 v2, 63, v0
    v_readfirstlane_b32 s48, v1
    s_and_b32 s77, s2, 7
    s_lshr_b32 s78, s2, 3
    s_mul_i32 s51, s78, 37
    s_lshr_b32 s51, s51, 8
    s_and_b32 s50, s77, 4
    s_add_u32 s50, s50, s51
    s_and_b32 s52, s77, 3
    s_sub_u32 s52, s52, s51
    s_mul_i32 s52, s52, 7
    s_add_u32 s49, s52, s78
    s_mov_b32 s58, 20971520
    s_mov_b32 s59, 0x00020000
    s_mov_b32 s62, 1605632
    s_mov_b32 s63, 0x00020000
    s_mov_b32 s66, 1605632
    s_mov_b32 s67, 0x00020000
    s_cmp_ge_u32 s78, 28
    s_cbranch_scc1 L_k2_aux
    s_cmp_ge_u32 s48, 4
    s_cbranch_scc1 L_k2_load
    v_lshrrev_b32 v6, 2, v2
    v_and_b32 v5, 3, v2
    v_and_b32 v7, 7, v6
    s_lshl_b32 s51, s48, 2
    s_add_u32 s51, s51, 0
    v_xor_b32 v4, s51, v7
    v_lshlrev_b32_e64 v4, 5, v4
    v_lshl_add_u32 v4, v6, 9, v4
    v_lshl_add_u32 v104, v5, 3, v4
    v_add_u32 v108, 49152, v104
    s_lshl_b32 s51, s48, 2
    s_add_u32 s51, s51, 1
    v_xor_b32 v4, s51, v7
    v_lshlrev_b32 v4, 5, v4
    v_lshl_add_u32 v4, v6, 9, v4
    v_lshl_add_u32 v105, v5, 3, v4
    v_add_u32 v109, 49152, v105
    s_lshl_b32 s51, s48, 2
    s_add_u32 s51, s51, 2
    v_xor_b32 v4, s51, v7
    v_lshlrev_b32 v4, 5, v4
    v_lshl_add_u32 v4, v6, 9, v4
    v_lshl_add_u32 v106, v5, 3, v4
    v_add_u32 v110, 49152, v106
    s_lshl_b32 s51, s48, 2
    s_add_u32 s51, s51, 3
    v_xor_b32 v4, s51, v7
    v_lshlrev_b32 v4, 5, v4
    v_lshl_add_u32 v4, v6, 9, v4
    v_lshl_add_u32 v107, v5, 3, v4
    v_add_u32 v111, 49152, v107
    v_bfe_u32 v7, v6, 1, 2
    v_xor_b32 v4, 0, v7
    v_lshlrev_b32 v4, 5, v4
    v_lshl_add_u32 v4, v6, 7, v4
    v_lshl_add_u32 v4, v5, 3, v4
    v_add_u32 v116, 16384, v4
    v_add_u32 v120, 49152, v116
    v_xor_b32 v4, 1, v7
    v_lshlrev_b32 v4, 5, v4
    v_lshl_add_u32 v4, v6, 7, v4
    v_lshl_add_u32 v4, v5, 3, v4
    v_add_u32 v117, 16384, v4
    v_add_u32 v121, 49152, v117
    v_xor_b32 v4, 2, v7
    v_lshlrev_b32 v4, 5, v4
    v_lshl_add_u32 v4, v6, 7, v4
    v_lshl_add_u32 v4, v5, 3, v4
    v_add_u32 v118, 16384, v4
    v_add_u32 v122, 49152, v118
    v_xor_b32 v4, 3, v7
    v_lshlrev_b32 v4, 5, v4
    v_lshl_add_u32 v4, v6, 7, v4
    v_lshl_add_u32 v4, v5, 3, v4
    v_add_u32 v119, 16384, v4
    v_add_u32 v123, 49152, v119
    s_lshr_b32 s51, s78, 2
    s_mul_i32 s72, s51, 229376
    s_add_u32 s72, s72, 2097152
    s_and_b32 s51, s78, 3
    s_lshl_b32 s52, s77, 2
    s_add_u32 s51, s51, s52
    s_mul_i32 s73, s51, 229376
    s_add_u32 s73, s73, 4194304
    s_mul_i32 s79, s51, 28
    s_mul_i32 s51, s48, 7
    s_lshr_b32 s52, s51, 1
    s_add_u32 s79, s79, s52
    s_lshl_b32 s79, s79, 7
    s_add_u32 s79, s79, 11796480
    s_lshl_b32 s51, s51, 10
    v_lshl_add_u32 v3, v2, 4, s51
    s_waitcnt lgkmcnt(0)
    s_load_dword s55, s[46:47], 0
    s_mov_b32 s56, s46
    s_mov_b32 s57, s47
    s_mov_b32 s60, s36
    s_mov_b32 s61, s37
    s_mov_b32 s64, s38
    s_mov_b32 s65, s39
    s_setprio 2
    s_barrier
    s_nop 0
    ds_read_b64_tr_b16 v[40:41], v104 offset:0
    ds_read_b64_tr_b16 v[42:43], v104 offset:8192
    ds_read_b64_tr_b16 v[44:45], v105 offset:0
    ds_read_b64_tr_b16 v[46:47], v105 offset:8192
    ds_read_b64_tr_b16 v[48:49], v106 offset:0
    ds_read_b64_tr_b16 v[50:51], v106 offset:8192
    ds_read_b64_tr_b16 v[52:53], v107 offset:0
    ds_read_b64_tr_b16 v[54:55], v107 offset:8192
    ds_read_b64_tr_b16 v[8:9], v116 offset:0
    ds_read_b64_tr_b16 v[10:11], v116 offset:2048
    ds_read_b64_tr_b16 v[12:13], v117 offset:0
    ds_read_b64_tr_b16 v[14:15], v117 offset:2048
    ds_read_b64_tr_b16 v[16:17], v118 offset:0
    ds_read_b64_tr_b16 v[18:19], v118 offset:2048
    ds_read_b64_tr_b16 v[20:21], v119 offset:0
    ds_read_b64_tr_b16 v[22:23], v119 offset:2048
    ds_read_b64_tr_b16 v[24:25], v116 offset:4096
    ds_read_b64_tr_b16 v[26:27], v116 offset:6144
    ds_read_b64_tr_b16 v[28:29], v117 offset:4096
    ds_read_b64_tr_b16 v[30:31], v117 offset:6144
    ds_read_b64_tr_b16 v[32:33], v118 offset:4096
    ds_read_b64_tr_b16 v[34:35], v118 offset:6144
    ds_read_b64_tr_b16 v[36:37], v119 offset:4096
    ds_read_b64_tr_b16 v[38:39], v119 offset:6144
    s_waitcnt lgkmcnt(0)
    s_barrier
    v_mfma_f32_16x16x32_bf16 v[128:131], v[8:11], v[40:43], 0
    ds_read_b64_tr_b16 v[88:89], v104 offset:24576
    v_mfma_f32_16x16x32_bf16 v[132:135], v[8:11], v[44:47], 0
    ds_read_b64_tr_b16 v[90:91], v104 offset:32768
    v_mfma_f32_16x16x32_bf16 v[136:139], v[8:11], v[48:51], 0
    ds_read_b64_tr_b16 v[92:93], v105 offset:24576
    v_mfma_f32_16x16x32_bf16 v[140:143], v[8:11], v[52:55], 0
    ds_read_b64_tr_b16 v[94:95], v105 offset:32768
    v_mfma_f32_16x16x32_bf16 v[144:147], v[12:15], v[40:43], 0
    ds_read_b64_tr_b16 v[96:97], v106 offset:24576
    v_mfma_f32_16x16x32_bf16 v[148:151], v[12:15], v[44:47], 0
    ds_read_b64_tr_b16 v[98:99], v106 offset:32768
    v_mfma_f32_16x16x32_bf16 v[152:155], v[12:15], v[48:51], 0
    ds_read_b64_tr_b16 v[100:101], v107 offset:24576
    v_mfma_f32_16x16x32_bf16 v[156:159], v[12:15], v[52:55], 0
    ds_read_b64_tr_b16 v[102:103], v107 offset:32768
    v_mfma_f32_16x16x32_bf16 v[160:163], v[16:19], v[40:43], 0
    ds_read_b64_tr_b16 v[56:57], v116 offset:24576
    v_mfma_f32_16x16x32_bf16 v[164:167], v[16:19], v[44:47], 0
    ds_read_b64_tr_b16 v[58:59], v116 offset:26624
    v_mfma_f32_16x16x32_bf16 v[168:171], v[16:19], v[48:51], 0
    ds_read_b64_tr_b16 v[60:61], v117 offset:24576
    v_mfma_f32_16x16x32_bf16 v[172:175], v[16:19], v[52:55], 0
    ds_read_b64_tr_b16 v[62:63], v117 offset:26624
    v_mfma_f32_16x16x32_bf16 v[176:179], v[20:23], v[40:43], 0
    ds_read_b64_tr_b16 v[64:65], v118 offset:24576
    v_mfma_f32_16x16x32_bf16 v[180:183], v[20:23], v[44:47], 0
    ds_read_b64_tr_b16 v[66:67], v118 offset:26624
    v_mfma_f32_16x16x32_bf16 v[184:187], v[20:23], v[48:51], 0
    ds_read_b64_tr_b16 v[68:69], v119 offset:24576
    v_mfma_f32_16x16x32_bf16 v[188:191], v[20:23], v[52:55], 0
    ds_read_b64_tr_b16 v[70:71], v119 offset:26624
    v_mfma_f32_16x16x32_bf16 v[192:195], v[24:27], v[40:43], 0
    ds_read_b64_tr_b16 v[72:73], v116 offset:28672
    v_mfma_f32_16x16x32_bf16 v[196:199], v[24:27], v[44:47], 0
    ds_read_b64_tr_b16 v[74:75], v116 offset:30720
    v_mfma_f32_16x16x32_bf16 v[200:203], v[24:27], v[48:51], 0
    ds_read_b64_tr_b16 v[76:77], v117 offset:28672
    v_mfma_f32_16x16x32_bf16 v[204:207], v[24:27], v[52:55], 0
    ds_read_b64_tr_b16 v[78:79], v117 offset:30720
    v_mfma_f32_16x16x32_bf16 v[208:211], v[28:31], v[40:43], 0
    ds_read_b64_tr_b16 v[80:81], v118 offset:28672
    v_mfma_f32_16x16x32_bf16 v[212:215], v[28:31], v[44:47], 0
    ds_read_b64_tr_b16 v[82:83], v118 offset:30720
    v_mfma_f32_16x16x32_bf16 v[216:219], v[28:31], v[48:51], 0
    ds_read_b64_tr_b16 v[84:85], v119 offset:28672
    v_mfma_f32_16x16x32_bf16 v[220:223], v[28:31], v[52:55], 0
    ds_read_b64_tr_b16 v[86:87], v119 offset:30720
    v_mfma_f32_16x16x32_bf16 v[224:227], v[32:35], v[40:43], 0
    v_mfma_f32_16x16x32_bf16 v[228:231], v[32:35], v[44:47], 0
    v_mfma_f32_16x16x32_bf16 v[232:235], v[32:35], v[48:51], 0
    v_mfma_f32_16x16x32_bf16 v[236:239], v[32:35], v[52:55], 0
    v_mfma_f32_16x16x32_bf16 v[240:243], v[36:39], v[40:43], 0
    v_mfma_f32_16x16x32_bf16 v[244:247], v[36:39], v[44:47], 0
    v_mfma_f32_16x16x32_bf16 v[248:251], v[36:39], v[48:51], 0
    v_mfma_f32_16x16x32_bf16 v[252:255], v[36:39], v[52:55], 0
    s_waitcnt lgkmcnt(0)
    s_barrier
    v_mfma_f32_16x16x32_bf16 v[128:131], v[56:59], v[88:91], v[128:131]
    ds_read_b64_tr_b16 v[40:41], v108 offset:0
    v_mfma_f32_16x16x32_bf16 v[132:135], v[56:59], v[92:95], v[132:135]
    ds_read_b64_tr_b16 v[42:43], v108 offset:8192
    v_mfma_f32_16x16x32_bf16 v[136:139], v[56:59], v[96:99], v[136:139]
    ds_read_b64_tr_b16 v[44:45], v109 offset:0
    v_mfma_f32_16x16x32_bf16 v[140:143], v[56:59], v[100:103], v[140:143]
    ds_read_b64_tr_b16 v[46:47], v109 offset:8192
    v_mfma_f32_16x16x32_bf16 v[144:147], v[60:63], v[88:91], v[144:147]
    ds_read_b64_tr_b16 v[48:49], v110 offset:0
    v_mfma_f32_16x16x32_bf16 v[148:151], v[60:63], v[92:95], v[148:151]
    ds_read_b64_tr_b16 v[50:51], v110 offset:8192
    v_mfma_f32_16x16x32_bf16 v[152:155], v[60:63], v[96:99], v[152:155]
    ds_read_b64_tr_b16 v[52:53], v111 offset:0
    v_mfma_f32_16x16x32_bf16 v[156:159], v[60:63], v[100:103], v[156:159]
    ds_read_b64_tr_b16 v[54:55], v111 offset:8192
    v_mfma_f32_16x16x32_bf16 v[160:163], v[64:67], v[88:91], v[160:163]
    ds_read_b64_tr_b16 v[8:9], v120 offset:0
    v_mfma_f32_16x16x32_bf16 v[164:167], v[64:67], v[92:95], v[164:167]
    ds_read_b64_tr_b16 v[10:11], v120 offset:2048
    v_mfma_f32_16x16x32_bf16 v[168:171], v[64:67], v[96:99], v[168:171]
    ds_read_b64_tr_b16 v[12:13], v121 offset:0
    v_mfma_f32_16x16x32_bf16 v[172:175], v[64:67], v[100:103], v[172:175]
    ds_read_b64_tr_b16 v[14:15], v121 offset:2048
    v_mfma_f32_16x16x32_bf16 v[176:179], v[68:71], v[88:91], v[176:179]
    ds_read_b64_tr_b16 v[16:17], v122 offset:0
    v_mfma_f32_16x16x32_bf16 v[180:183], v[68:71], v[92:95], v[180:183]
    ds_read_b64_tr_b16 v[18:19], v122 offset:2048
    v_mfma_f32_16x16x32_bf16 v[184:187], v[68:71], v[96:99], v[184:187]
    ds_read_b64_tr_b16 v[20:21], v123 offset:0
    v_mfma_f32_16x16x32_bf16 v[188:191], v[68:71], v[100:103], v[188:191]
    ds_read_b64_tr_b16 v[22:23], v123 offset:2048
    v_mfma_f32_16x16x32_bf16 v[192:195], v[72:75], v[88:91], v[192:195]
    ds_read_b64_tr_b16 v[24:25], v120 offset:4096
    v_mfma_f32_16x16x32_bf16 v[196:199], v[72:75], v[92:95], v[196:199]
    ds_read_b64_tr_b16 v[26:27], v120 offset:6144
    v_mfma_f32_16x16x32_bf16 v[200:203], v[72:75], v[96:99], v[200:203]
    ds_read_b64_tr_b16 v[28:29], v121 offset:4096
    v_mfma_f32_16x16x32_bf16 v[204:207], v[72:75], v[100:103], v[204:207]
    ds_read_b64_tr_b16 v[30:31], v121 offset:6144
    v_mfma_f32_16x16x32_bf16 v[208:211], v[76:79], v[88:91], v[208:211]
    ds_read_b64_tr_b16 v[32:33], v122 offset:4096
    v_mfma_f32_16x16x32_bf16 v[212:215], v[76:79], v[92:95], v[212:215]
    ds_read_b64_tr_b16 v[34:35], v122 offset:6144
    v_mfma_f32_16x16x32_bf16 v[216:219], v[76:79], v[96:99], v[216:219]
    ds_read_b64_tr_b16 v[36:37], v123 offset:4096
    v_mfma_f32_16x16x32_bf16 v[220:223], v[76:79], v[100:103], v[220:223]
    ds_read_b64_tr_b16 v[38:39], v123 offset:6144
    v_mfma_f32_16x16x32_bf16 v[224:227], v[80:83], v[88:91], v[224:227]
    v_mfma_f32_16x16x32_bf16 v[228:231], v[80:83], v[92:95], v[228:231]
    v_mfma_f32_16x16x32_bf16 v[232:235], v[80:83], v[96:99], v[232:235]
    v_mfma_f32_16x16x32_bf16 v[236:239], v[80:83], v[100:103], v[236:239]
    v_mfma_f32_16x16x32_bf16 v[240:243], v[84:87], v[88:91], v[240:243]
    v_mfma_f32_16x16x32_bf16 v[244:247], v[84:87], v[92:95], v[244:247]
    v_mfma_f32_16x16x32_bf16 v[248:251], v[84:87], v[96:99], v[248:251]
    v_mfma_f32_16x16x32_bf16 v[252:255], v[84:87], v[100:103], v[252:255]
    s_waitcnt lgkmcnt(0)
    s_barrier
    v_mfma_f32_16x16x32_bf16 v[128:131], v[8:11], v[40:43], v[128:131]
    ds_read_b64_tr_b16 v[88:89], v108 offset:24576
    v_mfma_f32_16x16x32_bf16 v[132:135], v[8:11], v[44:47], v[132:135]
    ds_read_b64_tr_b16 v[90:91], v108 offset:32768
    v_mfma_f32_16x16x32_bf16 v[136:139], v[8:11], v[48:51], v[136:139]
    ds_read_b64_tr_b16 v[92:93], v109 offset:24576
    v_mfma_f32_16x16x32_bf16 v[140:143], v[8:11], v[52:55], v[140:143]
    ds_read_b64_tr_b16 v[94:95], v109 offset:32768
    v_mfma_f32_16x16x32_bf16 v[144:147], v[12:15], v[40:43], v[144:147]
    ds_read_b64_tr_b16 v[96:97], v110 offset:24576
    v_mfma_f32_16x16x32_bf16 v[148:151], v[12:15], v[44:47], v[148:151]
    ds_read_b64_tr_b16 v[98:99], v110 offset:32768
    v_mfma_f32_16x16x32_bf16 v[152:155], v[12:15], v[48:51], v[152:155]
    ds_read_b64_tr_b16 v[100:101], v111 offset:24576
    v_mfma_f32_16x16x32_bf16 v[156:159], v[12:15], v[52:55], v[156:159]
    ds_read_b64_tr_b16 v[102:103], v111 offset:32768
    v_mfma_f32_16x16x32_bf16 v[160:163], v[16:19], v[40:43], v[160:163]
    ds_read_b64_tr_b16 v[56:57], v120 offset:24576
    v_mfma_f32_16x16x32_bf16 v[164:167], v[16:19], v[44:47], v[164:167]
    ds_read_b64_tr_b16 v[58:59], v120 offset:26624
    v_mfma_f32_16x16x32_bf16 v[168:171], v[16:19], v[48:51], v[168:171]
    ds_read_b64_tr_b16 v[60:61], v121 offset:24576
    v_mfma_f32_16x16x32_bf16 v[172:175], v[16:19], v[52:55], v[172:175]
    ds_read_b64_tr_b16 v[62:63], v121 offset:26624
    v_mfma_f32_16x16x32_bf16 v[176:179], v[20:23], v[40:43], v[176:179]
    ds_read_b64_tr_b16 v[64:65], v122 offset:24576
    v_mfma_f32_16x16x32_bf16 v[180:183], v[20:23], v[44:47], v[180:183]
    ds_read_b64_tr_b16 v[66:67], v122 offset:26624
    v_mfma_f32_16x16x32_bf16 v[184:187], v[20:23], v[48:51], v[184:187]
    ds_read_b64_tr_b16 v[68:69], v123 offset:24576
    v_mfma_f32_16x16x32_bf16 v[188:191], v[20:23], v[52:55], v[188:191]
    ds_read_b64_tr_b16 v[70:71], v123 offset:26624
    v_mfma_f32_16x16x32_bf16 v[192:195], v[24:27], v[40:43], v[192:195]
    ds_read_b64_tr_b16 v[72:73], v120 offset:28672
    v_mfma_f32_16x16x32_bf16 v[196:199], v[24:27], v[44:47], v[196:199]
    ds_read_b64_tr_b16 v[74:75], v120 offset:30720
    v_mfma_f32_16x16x32_bf16 v[200:203], v[24:27], v[48:51], v[200:203]
    ds_read_b64_tr_b16 v[76:77], v121 offset:28672
    v_mfma_f32_16x16x32_bf16 v[204:207], v[24:27], v[52:55], v[204:207]
    ds_read_b64_tr_b16 v[78:79], v121 offset:30720
    v_mfma_f32_16x16x32_bf16 v[208:211], v[28:31], v[40:43], v[208:211]
    ds_read_b64_tr_b16 v[80:81], v122 offset:28672
    v_mfma_f32_16x16x32_bf16 v[212:215], v[28:31], v[44:47], v[212:215]
    ds_read_b64_tr_b16 v[82:83], v122 offset:30720
    v_mfma_f32_16x16x32_bf16 v[216:219], v[28:31], v[48:51], v[216:219]
    ds_read_b64_tr_b16 v[84:85], v123 offset:28672
    v_mfma_f32_16x16x32_bf16 v[220:223], v[28:31], v[52:55], v[220:223]
    ds_read_b64_tr_b16 v[86:87], v123 offset:30720
    v_mfma_f32_16x16x32_bf16 v[224:227], v[32:35], v[40:43], v[224:227]
    v_mfma_f32_16x16x32_bf16 v[228:231], v[32:35], v[44:47], v[228:231]
    v_mfma_f32_16x16x32_bf16 v[232:235], v[32:35], v[48:51], v[232:235]
    v_mfma_f32_16x16x32_bf16 v[236:239], v[32:35], v[52:55], v[236:239]
    v_mfma_f32_16x16x32_bf16 v[240:243], v[36:39], v[40:43], v[240:243]
    v_mfma_f32_16x16x32_bf16 v[244:247], v[36:39], v[44:47], v[244:247]
    v_mfma_f32_16x16x32_bf16 v[248:251], v[36:39], v[48:51], v[248:251]
    v_mfma_f32_16x16x32_bf16 v[252:255], v[36:39], v[52:55], v[252:255]
    s_waitcnt lgkmcnt(0)
    s_barrier
    v_mfma_f32_16x16x32_bf16 v[128:131], v[56:59], v[88:91], v[128:131]
    ds_read_b64_tr_b16 v[40:41], v104 offset:0
    v_mfma_f32_16x16x32_bf16 v[132:135], v[56:59], v[92:95], v[132:135]
    ds_read_b64_tr_b16 v[42:43], v104 offset:8192
    v_mfma_f32_16x16x32_bf16 v[136:139], v[56:59], v[96:99], v[136:139]
    ds_read_b64_tr_b16 v[44:45], v105 offset:0
    v_mfma_f32_16x16x32_bf16 v[140:143], v[56:59], v[100:103], v[140:143]
    ds_read_b64_tr_b16 v[46:47], v105 offset:8192
    v_mfma_f32_16x16x32_bf16 v[144:147], v[60:63], v[88:91], v[144:147]
    ds_read_b64_tr_b16 v[48:49], v106 offset:0
    v_mfma_f32_16x16x32_bf16 v[148:151], v[60:63], v[92:95], v[148:151]
    ds_read_b64_tr_b16 v[50:51], v106 offset:8192
    v_mfma_f32_16x16x32_bf16 v[152:155], v[60:63], v[96:99], v[152:155]
    ds_read_b64_tr_b16 v[52:53], v107 offset:0
    v_mfma_f32_16x16x32_bf16 v[156:159], v[60:63], v[100:103], v[156:159]
    ds_read_b64_tr_b16 v[54:55], v107 offset:8192
    v_mfma_f32_16x16x32_bf16 v[160:163], v[64:67], v[88:91], v[160:163]
    ds_read_b64_tr_b16 v[8:9], v116 offset:0
    v_mfma_f32_16x16x32_bf16 v[164:167], v[64:67], v[92:95], v[164:167]
    ds_read_b64_tr_b16 v[10:11], v116 offset:2048
    v_mfma_f32_16x16x32_bf16 v[168:171], v[64:67], v[96:99], v[168:171]
    ds_read_b64_tr_b16 v[12:13], v117 offset:0
    v_mfma_f32_16x16x32_bf16 v[172:175], v[64:67], v[100:103], v[172:175]
    ds_read_b64_tr_b16 v[14:15], v117 offset:2048
    v_mfma_f32_16x16x32_bf16 v[176:179], v[68:71], v[88:91], v[176:179]
    ds_read_b64_tr_b16 v[16:17], v118 offset:0
    v_mfma_f32_16x16x32_bf16 v[180:183], v[68:71], v[92:95], v[180:183]
    ds_read_b64_tr_b16 v[18:19], v118 offset:2048
    v_mfma_f32_16x16x32_bf16 v[184:187], v[68:71], v[96:99], v[184:187]
    ds_read_b64_tr_b16 v[20:21], v119 offset:0
    v_mfma_f32_16x16x32_bf16 v[188:191], v[68:71], v[100:103], v[188:191]
    ds_read_b64_tr_b16 v[22:23], v119 offset:2048
    v_mfma_f32_16x16x32_bf16 v[192:195], v[72:75], v[88:91], v[192:195]
    ds_read_b64_tr_b16 v[24:25], v116 offset:4096
    v_mfma_f32_16x16x32_bf16 v[196:199], v[72:75], v[92:95], v[196:199]
    ds_read_b64_tr_b16 v[26:27], v116 offset:6144
    v_mfma_f32_16x16x32_bf16 v[200:203], v[72:75], v[96:99], v[200:203]
    ds_read_b64_tr_b16 v[28:29], v117 offset:4096
    v_mfma_f32_16x16x32_bf16 v[204:207], v[72:75], v[100:103], v[204:207]
    ds_read_b64_tr_b16 v[30:31], v117 offset:6144
    v_mfma_f32_16x16x32_bf16 v[208:211], v[76:79], v[88:91], v[208:211]
    ds_read_b64_tr_b16 v[32:33], v118 offset:4096
    v_mfma_f32_16x16x32_bf16 v[212:215], v[76:79], v[92:95], v[212:215]
    ds_read_b64_tr_b16 v[34:35], v118 offset:6144
    v_mfma_f32_16x16x32_bf16 v[216:219], v[76:79], v[96:99], v[216:219]
    ds_read_b64_tr_b16 v[36:37], v119 offset:4096
    v_mfma_f32_16x16x32_bf16 v[220:223], v[76:79], v[100:103], v[220:223]
    ds_read_b64_tr_b16 v[38:39], v119 offset:6144
    v_mfma_f32_16x16x32_bf16 v[224:227], v[80:83], v[88:91], v[224:227]
    v_mfma_f32_16x16x32_bf16 v[228:231], v[80:83], v[92:95], v[228:231]
    v_mfma_f32_16x16x32_bf16 v[232:235], v[80:83], v[96:99], v[232:235]
    v_mfma_f32_16x16x32_bf16 v[236:239], v[80:83], v[100:103], v[236:239]
    v_mfma_f32_16x16x32_bf16 v[240:243], v[84:87], v[88:91], v[240:243]
    v_mfma_f32_16x16x32_bf16 v[244:247], v[84:87], v[92:95], v[244:247]
    v_mfma_f32_16x16x32_bf16 v[248:251], v[84:87], v[96:99], v[248:251]
    v_mfma_f32_16x16x32_bf16 v[252:255], v[84:87], v[100:103], v[252:255]
    s_waitcnt lgkmcnt(0)
    s_barrier
    v_mfma_f32_16x16x32_bf16 v[128:131], v[8:11], v[40:43], v[128:131]
    ds_read_b64_tr_b16 v[88:89], v104 offset:24576
    v_mfma_f32_16x16x32_bf16 v[132:135], v[8:11], v[44:47], v[132:135]
    ds_read_b64_tr_b16 v[90:91], v104 offset:32768
    v_mfma_f32_16x16x32_bf16 v[136:139], v[8:11], v[48:51], v[136:139]
    ds_read_b64_tr_b16 v[92:93], v105 offset:24576
    v_mfma_f32_16x16x32_bf16 v[140:143], v[8:11], v[52:55], v[140:143]
    ds_read_b64_tr_b16 v[94:95], v105 offset:32768
    v_mfma_f32_16x16x32_bf16 v[144:147], v[12:15], v[40:43], v[144:147]
    ds_read_b64_tr_b16 v[96:97], v106 offset:24576
    v_mfma_f32_16x16x32_bf16 v[148:151], v[12:15], v[44:47], v[148:151]
    ds_read_b64_tr_b16 v[98:99], v106 offset:32768
    v_mfma_f32_16x16x32_bf16 v[152:155], v[12:15], v[48:51], v[152:155]
    ds_read_b64_tr_b16 v[100:101], v107 offset:24576
    v_mfma_f32_16x16x32_bf16 v[156:159], v[12:15], v[52:55], v[156:159]
    ds_read_b64_tr_b16 v[102:103], v107 offset:32768
    v_mfma_f32_16x16x32_bf16 v[160:163], v[16:19], v[40:43], v[160:163]
    ds_read_b64_tr_b16 v[56:57], v116 offset:24576
    v_mfma_f32_16x16x32_bf16 v[164:167], v[16:19], v[44:47], v[164:167]
    ds_read_b64_tr_b16 v[58:59], v116 offset:26624
    v_mfma_f32_16x16x32_bf16 v[168:171], v[16:19], v[48:51], v[168:171]
    ds_read_b64_tr_b16 v[60:61], v117 offset:24576
    v_mfma_f32_16x16x32_bf16 v[172:175], v[16:19], v[52:55], v[172:175]
    ds_read_b64_tr_b16 v[62:63], v117 offset:26624
    v_mfma_f32_16x16x32_bf16 v[176:179], v[20:23], v[40:43], v[176:179]
    ds_read_b64_tr_b16 v[64:65], v118 offset:24576
    v_mfma_f32_16x16x32_bf16 v[180:183], v[20:23], v[44:47], v[180:183]
    ds_read_b64_tr_b16 v[66:67], v118 offset:26624
    v_mfma_f32_16x16x32_bf16 v[184:187], v[20:23], v[48:51], v[184:187]
    ds_read_b64_tr_b16 v[68:69], v119 offset:24576
    v_mfma_f32_16x16x32_bf16 v[188:191], v[20:23], v[52:55], v[188:191]
    ds_read_b64_tr_b16 v[70:71], v119 offset:26624
    v_mfma_f32_16x16x32_bf16 v[192:195], v[24:27], v[40:43], v[192:195]
    ds_read_b64_tr_b16 v[72:73], v116 offset:28672
    v_mfma_f32_16x16x32_bf16 v[196:199], v[24:27], v[44:47], v[196:199]
    ds_read_b64_tr_b16 v[74:75], v116 offset:30720
    v_mfma_f32_16x16x32_bf16 v[200:203], v[24:27], v[48:51], v[200:203]
    ds_read_b64_tr_b16 v[76:77], v117 offset:28672
    v_mfma_f32_16x16x32_bf16 v[204:207], v[24:27], v[52:55], v[204:207]
    ds_read_b64_tr_b16 v[78:79], v117 offset:30720
    v_mfma_f32_16x16x32_bf16 v[208:211], v[28:31], v[40:43], v[208:211]
    ds_read_b64_tr_b16 v[80:81], v118 offset:28672
    v_mfma_f32_16x16x32_bf16 v[212:215], v[28:31], v[44:47], v[212:215]
    ds_read_b64_tr_b16 v[82:83], v118 offset:30720
    v_mfma_f32_16x16x32_bf16 v[216:219], v[28:31], v[48:51], v[216:219]
    ds_read_b64_tr_b16 v[84:85], v119 offset:28672
    v_mfma_f32_16x16x32_bf16 v[220:223], v[28:31], v[52:55], v[220:223]
    ds_read_b64_tr_b16 v[86:87], v119 offset:30720
    v_mfma_f32_16x16x32_bf16 v[224:227], v[32:35], v[40:43], v[224:227]
    v_mfma_f32_16x16x32_bf16 v[228:231], v[32:35], v[44:47], v[228:231]
    v_mfma_f32_16x16x32_bf16 v[232:235], v[32:35], v[48:51], v[232:235]
    v_mfma_f32_16x16x32_bf16 v[236:239], v[32:35], v[52:55], v[236:239]
    v_mfma_f32_16x16x32_bf16 v[240:243], v[36:39], v[40:43], v[240:243]
    v_mfma_f32_16x16x32_bf16 v[244:247], v[36:39], v[44:47], v[244:247]
    v_mfma_f32_16x16x32_bf16 v[248:251], v[36:39], v[48:51], v[248:251]
    v_mfma_f32_16x16x32_bf16 v[252:255], v[36:39], v[52:55], v[252:255]
    s_waitcnt lgkmcnt(0)
    s_barrier
    v_mfma_f32_16x16x32_bf16 v[128:131], v[56:59], v[88:91], v[128:131]
    ds_read_b64_tr_b16 v[40:41], v108 offset:0
    v_mfma_f32_16x16x32_bf16 v[132:135], v[56:59], v[92:95], v[132:135]
    ds_read_b64_tr_b16 v[42:43], v108 offset:8192
    v_mfma_f32_16x16x32_bf16 v[136:139], v[56:59], v[96:99], v[136:139]
    ds_read_b64_tr_b16 v[44:45], v109 offset:0
    v_mfma_f32_16x16x32_bf16 v[140:143], v[56:59], v[100:103], v[140:143]
    ds_read_b64_tr_b16 v[46:47], v109 offset:8192
    v_mfma_f32_16x16x32_bf16 v[144:147], v[60:63], v[88:91], v[144:147]
    ds_read_b64_tr_b16 v[48:49], v110 offset:0
    v_mfma_f32_16x16x32_bf16 v[148:151], v[60:63], v[92:95], v[148:151]
    ds_read_b64_tr_b16 v[50:51], v110 offset:8192
    v_mfma_f32_16x16x32_bf16 v[152:155], v[60:63], v[96:99], v[152:155]
    ds_read_b64_tr_b16 v[52:53], v111 offset:0
    v_mfma_f32_16x16x32_bf16 v[156:159], v[60:63], v[100:103], v[156:159]
    ds_read_b64_tr_b16 v[54:55], v111 offset:8192
    v_mfma_f32_16x16x32_bf16 v[160:163], v[64:67], v[88:91], v[160:163]
    ds_read_b64_tr_b16 v[8:9], v120 offset:0
    v_mfma_f32_16x16x32_bf16 v[164:167], v[64:67], v[92:95], v[164:167]
    ds_read_b64_tr_b16 v[10:11], v120 offset:2048
    v_mfma_f32_16x16x32_bf16 v[168:171], v[64:67], v[96:99], v[168:171]
    ds_read_b64_tr_b16 v[12:13], v121 offset:0
    v_mfma_f32_16x16x32_bf16 v[172:175], v[64:67], v[100:103], v[172:175]
    ds_read_b64_tr_b16 v[14:15], v121 offset:2048
    v_mfma_f32_16x16x32_bf16 v[176:179], v[68:71], v[88:91], v[176:179]
    ds_read_b64_tr_b16 v[16:17], v122 offset:0
    v_mfma_f32_16x16x32_bf16 v[180:183], v[68:71], v[92:95], v[180:183]
    ds_read_b64_tr_b16 v[18:19], v122 offset:2048
    v_mfma_f32_16x16x32_bf16 v[184:187], v[68:71], v[96:99], v[184:187]
    ds_read_b64_tr_b16 v[20:21], v123 offset:0
    v_mfma_f32_16x16x32_bf16 v[188:191], v[68:71], v[100:103], v[188:191]
    ds_read_b64_tr_b16 v[22:23], v123 offset:2048
    v_mfma_f32_16x16x32_bf16 v[192:195], v[72:75], v[88:91], v[192:195]
    ds_read_b64_tr_b16 v[24:25], v120 offset:4096
    v_mfma_f32_16x16x32_bf16 v[196:199], v[72:75], v[92:95], v[196:199]
    ds_read_b64_tr_b16 v[26:27], v120 offset:6144
    v_mfma_f32_16x16x32_bf16 v[200:203], v[72:75], v[96:99], v[200:203]
    ds_read_b64_tr_b16 v[28:29], v121 offset:4096
    v_mfma_f32_16x16x32_bf16 v[204:207], v[72:75], v[100:103], v[204:207]
    ds_read_b64_tr_b16 v[30:31], v121 offset:6144
    v_mfma_f32_16x16x32_bf16 v[208:211], v[76:79], v[88:91], v[208:211]
    ds_read_b64_tr_b16 v[32:33], v122 offset:4096
    v_mfma_f32_16x16x32_bf16 v[212:215], v[76:79], v[92:95], v[212:215]
    ds_read_b64_tr_b16 v[34:35], v122 offset:6144
    v_mfma_f32_16x16x32_bf16 v[216:219], v[76:79], v[96:99], v[216:219]
    ds_read_b64_tr_b16 v[36:37], v123 offset:4096
    v_mfma_f32_16x16x32_bf16 v[220:223], v[76:79], v[100:103], v[220:223]
    ds_read_b64_tr_b16 v[38:39], v123 offset:6144
    v_mfma_f32_16x16x32_bf16 v[224:227], v[80:83], v[88:91], v[224:227]
    v_mfma_f32_16x16x32_bf16 v[228:231], v[80:83], v[92:95], v[228:231]
    v_mfma_f32_16x16x32_bf16 v[232:235], v[80:83], v[96:99], v[232:235]
    v_mfma_f32_16x16x32_bf16 v[236:239], v[80:83], v[100:103], v[236:239]
    v_mfma_f32_16x16x32_bf16 v[240:243], v[84:87], v[88:91], v[240:243]
    v_mfma_f32_16x16x32_bf16 v[244:247], v[84:87], v[92:95], v[244:247]
    v_mfma_f32_16x16x32_bf16 v[248:251], v[84:87], v[96:99], v[248:251]
    v_mfma_f32_16x16x32_bf16 v[252:255], v[84:87], v[100:103], v[252:255]
    s_waitcnt lgkmcnt(0)
    s_barrier
    v_mfma_f32_16x16x32_bf16 v[128:131], v[8:11], v[40:43], v[128:131]
    ds_read_b64_tr_b16 v[88:89], v108 offset:24576
    v_mfma_f32_16x16x32_bf16 v[132:135], v[8:11], v[44:47], v[132:135]
    ds_read_b64_tr_b16 v[90:91], v108 offset:32768
    v_mfma_f32_16x16x32_bf16 v[136:139], v[8:11], v[48:51], v[136:139]
    ds_read_b64_tr_b16 v[92:93], v109 offset:24576
    v_mfma_f32_16x16x32_bf16 v[140:143], v[8:11], v[52:55], v[140:143]
    ds_read_b64_tr_b16 v[94:95], v109 offset:32768
    v_mfma_f32_16x16x32_bf16 v[144:147], v[12:15], v[40:43], v[144:147]
    ds_read_b64_tr_b16 v[96:97], v110 offset:24576
    v_mfma_f32_16x16x32_bf16 v[148:151], v[12:15], v[44:47], v[148:151]
    ds_read_b64_tr_b16 v[98:99], v110 offset:32768
    v_mfma_f32_16x16x32_bf16 v[152:155], v[12:15], v[48:51], v[152:155]
    ds_read_b64_tr_b16 v[100:101], v111 offset:24576
    v_mfma_f32_16x16x32_bf16 v[156:159], v[12:15], v[52:55], v[156:159]
    ds_read_b64_tr_b16 v[102:103], v111 offset:32768
    v_mfma_f32_16x16x32_bf16 v[160:163], v[16:19], v[40:43], v[160:163]
    ds_read_b64_tr_b16 v[56:57], v120 offset:24576
    v_mfma_f32_16x16x32_bf16 v[164:167], v[16:19], v[44:47], v[164:167]
    ds_read_b64_tr_b16 v[58:59], v120 offset:26624
    v_mfma_f32_16x16x32_bf16 v[168:171], v[16:19], v[48:51], v[168:171]
    ds_read_b64_tr_b16 v[60:61], v121 offset:24576
    v_mfma_f32_16x16x32_bf16 v[172:175], v[16:19], v[52:55], v[172:175]
    ds_read_b64_tr_b16 v[62:63], v121 offset:26624
    v_mfma_f32_16x16x32_bf16 v[176:179], v[20:23], v[40:43], v[176:179]
    ds_read_b64_tr_b16 v[64:65], v122 offset:24576
    v_mfma_f32_16x16x32_bf16 v[180:183], v[20:23], v[44:47], v[180:183]
    ds_read_b64_tr_b16 v[66:67], v122 offset:26624
    v_mfma_f32_16x16x32_bf16 v[184:187], v[20:23], v[48:51], v[184:187]
    ds_read_b64_tr_b16 v[68:69], v123 offset:24576
    v_mfma_f32_16x16x32_bf16 v[188:191], v[20:23], v[52:55], v[188:191]
    ds_read_b64_tr_b16 v[70:71], v123 offset:26624
    v_mfma_f32_16x16x32_bf16 v[192:195], v[24:27], v[40:43], v[192:195]
    ds_read_b64_tr_b16 v[72:73], v120 offset:28672
    v_mfma_f32_16x16x32_bf16 v[196:199], v[24:27], v[44:47], v[196:199]
    ds_read_b64_tr_b16 v[74:75], v120 offset:30720
    v_mfma_f32_16x16x32_bf16 v[200:203], v[24:27], v[48:51], v[200:203]
    ds_read_b64_tr_b16 v[76:77], v121 offset:28672
    v_mfma_f32_16x16x32_bf16 v[204:207], v[24:27], v[52:55], v[204:207]
    ds_read_b64_tr_b16 v[78:79], v121 offset:30720
    v_mfma_f32_16x16x32_bf16 v[208:211], v[28:31], v[40:43], v[208:211]
    ds_read_b64_tr_b16 v[80:81], v122 offset:28672
    v_mfma_f32_16x16x32_bf16 v[212:215], v[28:31], v[44:47], v[212:215]
    ds_read_b64_tr_b16 v[82:83], v122 offset:30720
    v_mfma_f32_16x16x32_bf16 v[216:219], v[28:31], v[48:51], v[216:219]
    ds_read_b64_tr_b16 v[84:85], v123 offset:28672
    v_mfma_f32_16x16x32_bf16 v[220:223], v[28:31], v[52:55], v[220:223]
    ds_read_b64_tr_b16 v[86:87], v123 offset:30720
    v_mfma_f32_16x16x32_bf16 v[224:227], v[32:35], v[40:43], v[224:227]
    v_mfma_f32_16x16x32_bf16 v[228:231], v[32:35], v[44:47], v[228:231]
    v_mfma_f32_16x16x32_bf16 v[232:235], v[32:35], v[48:51], v[232:235]
    v_mfma_f32_16x16x32_bf16 v[236:239], v[32:35], v[52:55], v[236:239]
    v_mfma_f32_16x16x32_bf16 v[240:243], v[36:39], v[40:43], v[240:243]
    v_mfma_f32_16x16x32_bf16 v[244:247], v[36:39], v[44:47], v[244:247]
    v_mfma_f32_16x16x32_bf16 v[248:251], v[36:39], v[48:51], v[248:251]
    v_mfma_f32_16x16x32_bf16 v[252:255], v[36:39], v[52:55], v[252:255]
    s_waitcnt lgkmcnt(0)
    s_barrier
    v_mfma_f32_16x16x32_bf16 v[128:131], v[56:59], v[88:91], v[128:131]
    ds_read_b64_tr_b16 v[40:41], v104 offset:0
    v_mfma_f32_16x16x32_bf16 v[132:135], v[56:59], v[92:95], v[132:135]
    ds_read_b64_tr_b16 v[42:43], v104 offset:8192
    v_mfma_f32_16x16x32_bf16 v[136:139], v[56:59], v[96:99], v[136:139]
    ds_read_b64_tr_b16 v[44:45], v105 offset:0
    v_mfma_f32_16x16x32_bf16 v[140:143], v[56:59], v[100:103], v[140:143]
    ds_read_b64_tr_b16 v[46:47], v105 offset:8192
    v_mfma_f32_16x16x32_bf16 v[144:147], v[60:63], v[88:91], v[144:147]
    ds_read_b64_tr_b16 v[48:49], v106 offset:0
    v_mfma_f32_16x16x32_bf16 v[148:151], v[60:63], v[92:95], v[148:151]
    ds_read_b64_tr_b16 v[50:51], v106 offset:8192
    v_mfma_f32_16x16x32_bf16 v[152:155], v[60:63], v[96:99], v[152:155]
    ds_read_b64_tr_b16 v[52:53], v107 offset:0
    v_mfma_f32_16x16x32_bf16 v[156:159], v[60:63], v[100:103], v[156:159]
    ds_read_b64_tr_b16 v[54:55], v107 offset:8192
    v_mfma_f32_16x16x32_bf16 v[160:163], v[64:67], v[88:91], v[160:163]
    ds_read_b64_tr_b16 v[8:9], v116 offset:0
    v_mfma_f32_16x16x32_bf16 v[164:167], v[64:67], v[92:95], v[164:167]
    ds_read_b64_tr_b16 v[10:11], v116 offset:2048
    v_mfma_f32_16x16x32_bf16 v[168:171], v[64:67], v[96:99], v[168:171]
    ds_read_b64_tr_b16 v[12:13], v117 offset:0
    v_mfma_f32_16x16x32_bf16 v[172:175], v[64:67], v[100:103], v[172:175]
    ds_read_b64_tr_b16 v[14:15], v117 offset:2048
    v_mfma_f32_16x16x32_bf16 v[176:179], v[68:71], v[88:91], v[176:179]
    ds_read_b64_tr_b16 v[16:17], v118 offset:0
    v_mfma_f32_16x16x32_bf16 v[180:183], v[68:71], v[92:95], v[180:183]
    ds_read_b64_tr_b16 v[18:19], v118 offset:2048
    v_mfma_f32_16x16x32_bf16 v[184:187], v[68:71], v[96:99], v[184:187]
    ds_read_b64_tr_b16 v[20:21], v119 offset:0
    v_mfma_f32_16x16x32_bf16 v[188:191], v[68:71], v[100:103], v[188:191]
    ds_read_b64_tr_b16 v[22:23], v119 offset:2048
    v_mfma_f32_16x16x32_bf16 v[192:195], v[72:75], v[88:91], v[192:195]
    ds_read_b64_tr_b16 v[24:25], v116 offset:4096
    v_mfma_f32_16x16x32_bf16 v[196:199], v[72:75], v[92:95], v[196:199]
    ds_read_b64_tr_b16 v[26:27], v116 offset:6144
    v_mfma_f32_16x16x32_bf16 v[200:203], v[72:75], v[96:99], v[200:203]
    ds_read_b64_tr_b16 v[28:29], v117 offset:4096
    v_mfma_f32_16x16x32_bf16 v[204:207], v[72:75], v[100:103], v[204:207]
    ds_read_b64_tr_b16 v[30:31], v117 offset:6144
    v_mfma_f32_16x16x32_bf16 v[208:211], v[76:79], v[88:91], v[208:211]
    ds_read_b64_tr_b16 v[32:33], v118 offset:4096
    v_mfma_f32_16x16x32_bf16 v[212:215], v[76:79], v[92:95], v[212:215]
    ds_read_b64_tr_b16 v[34:35], v118 offset:6144
    v_mfma_f32_16x16x32_bf16 v[216:219], v[76:79], v[96:99], v[216:219]
    ds_read_b64_tr_b16 v[36:37], v119 offset:4096
    v_mfma_f32_16x16x32_bf16 v[220:223], v[76:79], v[100:103], v[220:223]
    ds_read_b64_tr_b16 v[38:39], v119 offset:6144
    v_mfma_f32_16x16x32_bf16 v[224:227], v[80:83], v[88:91], v[224:227]
    v_mfma_f32_16x16x32_bf16 v[228:231], v[80:83], v[92:95], v[228:231]
    v_mfma_f32_16x16x32_bf16 v[232:235], v[80:83], v[96:99], v[232:235]
    v_mfma_f32_16x16x32_bf16 v[236:239], v[80:83], v[100:103], v[236:239]
    v_mfma_f32_16x16x32_bf16 v[240:243], v[84:87], v[88:91], v[240:243]
    v_mfma_f32_16x16x32_bf16 v[244:247], v[84:87], v[92:95], v[244:247]
    v_mfma_f32_16x16x32_bf16 v[248:251], v[84:87], v[96:99], v[248:251]
    v_mfma_f32_16x16x32_bf16 v[252:255], v[84:87], v[100:103], v[252:255]
    s_waitcnt lgkmcnt(0)
    s_barrier
    v_mfma_f32_16x16x32_bf16 v[128:131], v[8:11], v[40:43], v[128:131]
    ds_read_b64_tr_b16 v[88:89], v104 offset:24576
    v_mfma_f32_16x16x32_bf16 v[132:135], v[8:11], v[44:47], v[132:135]
    ds_read_b64_tr_b16 v[90:91], v104 offset:32768
    v_mfma_f32_16x16x32_bf16 v[136:139], v[8:11], v[48:51], v[136:139]
    ds_read_b64_tr_b16 v[92:93], v105 offset:24576
    v_mfma_f32_16x16x32_bf16 v[140:143], v[8:11], v[52:55], v[140:143]
    ds_read_b64_tr_b16 v[94:95], v105 offset:32768
    v_mfma_f32_16x16x32_bf16 v[144:147], v[12:15], v[40:43], v[144:147]
    ds_read_b64_tr_b16 v[96:97], v106 offset:24576
    v_mfma_f32_16x16x32_bf16 v[148:151], v[12:15], v[44:47], v[148:151]
    ds_read_b64_tr_b16 v[98:99], v106 offset:32768
    v_mfma_f32_16x16x32_bf16 v[152:155], v[12:15], v[48:51], v[152:155]
    ds_read_b64_tr_b16 v[100:101], v107 offset:24576
    v_mfma_f32_16x16x32_bf16 v[156:159], v[12:15], v[52:55], v[156:159]
    ds_read_b64_tr_b16 v[102:103], v107 offset:32768
    v_mfma_f32_16x16x32_bf16 v[160:163], v[16:19], v[40:43], v[160:163]
    ds_read_b64_tr_b16 v[56:57], v116 offset:24576
    v_mfma_f32_16x16x32_bf16 v[164:167], v[16:19], v[44:47], v[164:167]
    ds_read_b64_tr_b16 v[58:59], v116 offset:26624
    v_mfma_f32_16x16x32_bf16 v[168:171], v[16:19], v[48:51], v[168:171]
    ds_read_b64_tr_b16 v[60:61], v117 offset:24576
    v_mfma_f32_16x16x32_bf16 v[172:175], v[16:19], v[52:55], v[172:175]
    ds_read_b64_tr_b16 v[62:63], v117 offset:26624
    v_mfma_f32_16x16x32_bf16 v[176:179], v[20:23], v[40:43], v[176:179]
    ds_read_b64_tr_b16 v[64:65], v118 offset:24576
    v_mfma_f32_16x16x32_bf16 v[180:183], v[20:23], v[44:47], v[180:183]
    ds_read_b64_tr_b16 v[66:67], v118 offset:26624
    v_mfma_f32_16x16x32_bf16 v[184:187], v[20:23], v[48:51], v[184:187]
    ds_read_b64_tr_b16 v[68:69], v119 offset:24576
    v_mfma_f32_16x16x32_bf16 v[188:191], v[20:23], v[52:55], v[188:191]
    ds_read_b64_tr_b16 v[70:71], v119 offset:26624
    v_mfma_f32_16x16x32_bf16 v[192:195], v[24:27], v[40:43], v[192:195]
    ds_read_b64_tr_b16 v[72:73], v116 offset:28672
    v_mfma_f32_16x16x32_bf16 v[196:199], v[24:27], v[44:47], v[196:199]
    ds_read_b64_tr_b16 v[74:75], v116 offset:30720
    v_mfma_f32_16x16x32_bf16 v[200:203], v[24:27], v[48:51], v[200:203]
    ds_read_b64_tr_b16 v[76:77], v117 offset:28672
    v_mfma_f32_16x16x32_bf16 v[204:207], v[24:27], v[52:55], v[204:207]
    ds_read_b64_tr_b16 v[78:79], v117 offset:30720
    v_mfma_f32_16x16x32_bf16 v[208:211], v[28:31], v[40:43], v[208:211]
    ds_read_b64_tr_b16 v[80:81], v118 offset:28672
    v_mfma_f32_16x16x32_bf16 v[212:215], v[28:31], v[44:47], v[212:215]
    ds_read_b64_tr_b16 v[82:83], v118 offset:30720
    v_mfma_f32_16x16x32_bf16 v[216:219], v[28:31], v[48:51], v[216:219]
    ds_read_b64_tr_b16 v[84:85], v119 offset:28672
    v_mfma_f32_16x16x32_bf16 v[220:223], v[28:31], v[52:55], v[220:223]
    ds_read_b64_tr_b16 v[86:87], v119 offset:30720
    v_mfma_f32_16x16x32_bf16 v[224:227], v[32:35], v[40:43], v[224:227]
    v_mfma_f32_16x16x32_bf16 v[228:231], v[32:35], v[44:47], v[228:231]
    v_mfma_f32_16x16x32_bf16 v[232:235], v[32:35], v[48:51], v[232:235]
    v_mfma_f32_16x16x32_bf16 v[236:239], v[32:35], v[52:55], v[236:239]
    v_mfma_f32_16x16x32_bf16 v[240:243], v[36:39], v[40:43], v[240:243]
    v_mfma_f32_16x16x32_bf16 v[244:247], v[36:39], v[44:47], v[244:247]
    v_mfma_f32_16x16x32_bf16 v[248:251], v[36:39], v[48:51], v[248:251]
    v_mfma_f32_16x16x32_bf16 v[252:255], v[36:39], v[52:55], v[252:255]
    s_waitcnt lgkmcnt(0)
    s_barrier
    v_mfma_f32_16x16x32_bf16 v[128:131], v[56:59], v[88:91], v[128:131]
    ds_read_b64_tr_b16 v[40:41], v108 offset:0
    v_mfma_f32_16x16x32_bf16 v[132:135], v[56:59], v[92:95], v[132:135]
    ds_read_b64_tr_b16 v[42:43], v108 offset:8192
    v_mfma_f32_16x16x32_bf16 v[136:139], v[56:59], v[96:99], v[136:139]
    ds_read_b64_tr_b16 v[44:45], v109 offset:0
    v_mfma_f32_16x16x32_bf16 v[140:143], v[56:59], v[100:103], v[140:143]
    ds_read_b64_tr_b16 v[46:47], v109 offset:8192
    v_mfma_f32_16x16x32_bf16 v[144:147], v[60:63], v[88:91], v[144:147]
    ds_read_b64_tr_b16 v[48:49], v110 offset:0
    v_mfma_f32_16x16x32_bf16 v[148:151], v[60:63], v[92:95], v[148:151]
    ds_read_b64_tr_b16 v[50:51], v110 offset:8192
    v_mfma_f32_16x16x32_bf16 v[152:155], v[60:63], v[96:99], v[152:155]
    ds_read_b64_tr_b16 v[52:53], v111 offset:0
    v_mfma_f32_16x16x32_bf16 v[156:159], v[60:63], v[100:103], v[156:159]
    ds_read_b64_tr_b16 v[54:55], v111 offset:8192
    v_mfma_f32_16x16x32_bf16 v[160:163], v[64:67], v[88:91], v[160:163]
    ds_read_b64_tr_b16 v[8:9], v120 offset:0
    v_mfma_f32_16x16x32_bf16 v[164:167], v[64:67], v[92:95], v[164:167]
    ds_read_b64_tr_b16 v[10:11], v120 offset:2048
    v_mfma_f32_16x16x32_bf16 v[168:171], v[64:67], v[96:99], v[168:171]
    ds_read_b64_tr_b16 v[12:13], v121 offset:0
    v_mfma_f32_16x16x32_bf16 v[172:175], v[64:67], v[100:103], v[172:175]
    ds_read_b64_tr_b16 v[14:15], v121 offset:2048
    v_mfma_f32_16x16x32_bf16 v[176:179], v[68:71], v[88:91], v[176:179]
    ds_read_b64_tr_b16 v[16:17], v122 offset:0
    v_mfma_f32_16x16x32_bf16 v[180:183], v[68:71], v[92:95], v[180:183]
    ds_read_b64_tr_b16 v[18:19], v122 offset:2048
    v_mfma_f32_16x16x32_bf16 v[184:187], v[68:71], v[96:99], v[184:187]
    ds_read_b64_tr_b16 v[20:21], v123 offset:0
    v_mfma_f32_16x16x32_bf16 v[188:191], v[68:71], v[100:103], v[188:191]
    ds_read_b64_tr_b16 v[22:23], v123 offset:2048
    v_mfma_f32_16x16x32_bf16 v[192:195], v[72:75], v[88:91], v[192:195]
    ds_read_b64_tr_b16 v[24:25], v120 offset:4096
    v_mfma_f32_16x16x32_bf16 v[196:199], v[72:75], v[92:95], v[196:199]
    ds_read_b64_tr_b16 v[26:27], v120 offset:6144
    v_mfma_f32_16x16x32_bf16 v[200:203], v[72:75], v[96:99], v[200:203]
    ds_read_b64_tr_b16 v[28:29], v121 offset:4096
    v_mfma_f32_16x16x32_bf16 v[204:207], v[72:75], v[100:103], v[204:207]
    ds_read_b64_tr_b16 v[30:31], v121 offset:6144
    v_mfma_f32_16x16x32_bf16 v[208:211], v[76:79], v[88:91], v[208:211]
    ds_read_b64_tr_b16 v[32:33], v122 offset:4096
    v_mfma_f32_16x16x32_bf16 v[212:215], v[76:79], v[92:95], v[212:215]
    ds_read_b64_tr_b16 v[34:35], v122 offset:6144
    v_mfma_f32_16x16x32_bf16 v[216:219], v[76:79], v[96:99], v[216:219]
    ds_read_b64_tr_b16 v[36:37], v123 offset:4096
    v_mfma_f32_16x16x32_bf16 v[220:223], v[76:79], v[100:103], v[220:223]
    ds_read_b64_tr_b16 v[38:39], v123 offset:6144
    v_mfma_f32_16x16x32_bf16 v[224:227], v[80:83], v[88:91], v[224:227]
    v_mfma_f32_16x16x32_bf16 v[228:231], v[80:83], v[92:95], v[228:231]
    v_mfma_f32_16x16x32_bf16 v[232:235], v[80:83], v[96:99], v[232:235]
    v_mfma_f32_16x16x32_bf16 v[236:239], v[80:83], v[100:103], v[236:239]
    v_mfma_f32_16x16x32_bf16 v[240:243], v[84:87], v[88:91], v[240:243]
    v_mfma_f32_16x16x32_bf16 v[244:247], v[84:87], v[92:95], v[244:247]
    v_mfma_f32_16x16x32_bf16 v[248:251], v[84:87], v[96:99], v[248:251]
    v_mfma_f32_16x16x32_bf16 v[252:255], v[84:87], v[100:103], v[252:255]
    s_waitcnt lgkmcnt(0)
    s_barrier
    v_mfma_f32_16x16x32_bf16 v[128:131], v[8:11], v[40:43], v[128:131]
    ds_read_b64_tr_b16 v[88:89], v108 offset:24576
    v_mfma_f32_16x16x32_bf16 v[132:135], v[8:11], v[44:47], v[132:135]
    ds_read_b64_tr_b16 v[90:91], v108 offset:32768
    v_mfma_f32_16x16x32_bf16 v[136:139], v[8:11], v[48:51], v[136:139]
    ds_read_b64_tr_b16 v[92:93], v109 offset:24576
    v_mfma_f32_16x16x32_bf16 v[140:143], v[8:11], v[52:55], v[140:143]
    ds_read_b64_tr_b16 v[94:95], v109 offset:32768
    v_mfma_f32_16x16x32_bf16 v[144:147], v[12:15], v[40:43], v[144:147]
    ds_read_b64_tr_b16 v[96:97], v110 offset:24576
    v_mfma_f32_16x16x32_bf16 v[148:151], v[12:15], v[44:47], v[148:151]
    ds_read_b64_tr_b16 v[98:99], v110 offset:32768
    v_mfma_f32_16x16x32_bf16 v[152:155], v[12:15], v[48:51], v[152:155]
    ds_read_b64_tr_b16 v[100:101], v111 offset:24576
    v_mfma_f32_16x16x32_bf16 v[156:159], v[12:15], v[52:55], v[156:159]
    ds_read_b64_tr_b16 v[102:103], v111 offset:32768
    v_mfma_f32_16x16x32_bf16 v[160:163], v[16:19], v[40:43], v[160:163]
    ds_read_b64_tr_b16 v[56:57], v120 offset:24576
    v_mfma_f32_16x16x32_bf16 v[164:167], v[16:19], v[44:47], v[164:167]
    ds_read_b64_tr_b16 v[58:59], v120 offset:26624
    v_mfma_f32_16x16x32_bf16 v[168:171], v[16:19], v[48:51], v[168:171]
    ds_read_b64_tr_b16 v[60:61], v121 offset:24576
    v_mfma_f32_16x16x32_bf16 v[172:175], v[16:19], v[52:55], v[172:175]
    ds_read_b64_tr_b16 v[62:63], v121 offset:26624
    v_mfma_f32_16x16x32_bf16 v[176:179], v[20:23], v[40:43], v[176:179]
    ds_read_b64_tr_b16 v[64:65], v122 offset:24576
    v_mfma_f32_16x16x32_bf16 v[180:183], v[20:23], v[44:47], v[180:183]
    ds_read_b64_tr_b16 v[66:67], v122 offset:26624
    v_mfma_f32_16x16x32_bf16 v[184:187], v[20:23], v[48:51], v[184:187]
    ds_read_b64_tr_b16 v[68:69], v123 offset:24576
    v_mfma_f32_16x16x32_bf16 v[188:191], v[20:23], v[52:55], v[188:191]
    ds_read_b64_tr_b16 v[70:71], v123 offset:26624
    v_mfma_f32_16x16x32_bf16 v[192:195], v[24:27], v[40:43], v[192:195]
    ds_read_b64_tr_b16 v[72:73], v120 offset:28672
    v_mfma_f32_16x16x32_bf16 v[196:199], v[24:27], v[44:47], v[196:199]
    ds_read_b64_tr_b16 v[74:75], v120 offset:30720
    v_mfma_f32_16x16x32_bf16 v[200:203], v[24:27], v[48:51], v[200:203]
    ds_read_b64_tr_b16 v[76:77], v121 offset:28672
    v_mfma_f32_16x16x32_bf16 v[204:207], v[24:27], v[52:55], v[204:207]
    ds_read_b64_tr_b16 v[78:79], v121 offset:30720
    v_mfma_f32_16x16x32_bf16 v[208:211], v[28:31], v[40:43], v[208:211]
    ds_read_b64_tr_b16 v[80:81], v122 offset:28672
    v_mfma_f32_16x16x32_bf16 v[212:215], v[28:31], v[44:47], v[212:215]
    ds_read_b64_tr_b16 v[82:83], v122 offset:30720
    v_mfma_f32_16x16x32_bf16 v[216:219], v[28:31], v[48:51], v[216:219]
    ds_read_b64_tr_b16 v[84:85], v123 offset:28672
    v_mfma_f32_16x16x32_bf16 v[220:223], v[28:31], v[52:55], v[220:223]
    ds_read_b64_tr_b16 v[86:87], v123 offset:30720
    v_mfma_f32_16x16x32_bf16 v[224:227], v[32:35], v[40:43], v[224:227]
    v_mfma_f32_16x16x32_bf16 v[228:231], v[32:35], v[44:47], v[228:231]
    v_mfma_f32_16x16x32_bf16 v[232:235], v[32:35], v[48:51], v[232:235]
    v_mfma_f32_16x16x32_bf16 v[236:239], v[32:35], v[52:55], v[236:239]
    v_mfma_f32_16x16x32_bf16 v[240:243], v[36:39], v[40:43], v[240:243]
    v_mfma_f32_16x16x32_bf16 v[244:247], v[36:39], v[44:47], v[244:247]
    v_mfma_f32_16x16x32_bf16 v[248:251], v[36:39], v[48:51], v[248:251]
    v_mfma_f32_16x16x32_bf16 v[252:255], v[36:39], v[52:55], v[252:255]
    s_waitcnt lgkmcnt(0)
    s_barrier
    v_mfma_f32_16x16x32_bf16 v[128:131], v[56:59], v[88:91], v[128:131]
    ds_read_b64_tr_b16 v[40:41], v104 offset:0
    v_mfma_f32_16x16x32_bf16 v[132:135], v[56:59], v[92:95], v[132:135]
    ds_read_b64_tr_b16 v[42:43], v104 offset:8192
    v_mfma_f32_16x16x32_bf16 v[136:139], v[56:59], v[96:99], v[136:139]
    ds_read_b64_tr_b16 v[44:45], v105 offset:0
    v_mfma_f32_16x16x32_bf16 v[140:143], v[56:59], v[100:103], v[140:143]
    ds_read_b64_tr_b16 v[46:47], v105 offset:8192
    v_mfma_f32_16x16x32_bf16 v[144:147], v[60:63], v[88:91], v[144:147]
    ds_read_b64_tr_b16 v[48:49], v106 offset:0
    v_mfma_f32_16x16x32_bf16 v[148:151], v[60:63], v[92:95], v[148:151]
    ds_read_b64_tr_b16 v[50:51], v106 offset:8192
    v_mfma_f32_16x16x32_bf16 v[152:155], v[60:63], v[96:99], v[152:155]
    ds_read_b64_tr_b16 v[52:53], v107 offset:0
    v_mfma_f32_16x16x32_bf16 v[156:159], v[60:63], v[100:103], v[156:159]
    ds_read_b64_tr_b16 v[54:55], v107 offset:8192
    v_mfma_f32_16x16x32_bf16 v[160:163], v[64:67], v[88:91], v[160:163]
    ds_read_b64_tr_b16 v[8:9], v116 offset:0
    v_mfma_f32_16x16x32_bf16 v[164:167], v[64:67], v[92:95], v[164:167]
    ds_read_b64_tr_b16 v[10:11], v116 offset:2048
    v_mfma_f32_16x16x32_bf16 v[168:171], v[64:67], v[96:99], v[168:171]
    ds_read_b64_tr_b16 v[12:13], v117 offset:0
    v_mfma_f32_16x16x32_bf16 v[172:175], v[64:67], v[100:103], v[172:175]
    ds_read_b64_tr_b16 v[14:15], v117 offset:2048
    v_mfma_f32_16x16x32_bf16 v[176:179], v[68:71], v[88:91], v[176:179]
    ds_read_b64_tr_b16 v[16:17], v118 offset:0
    v_mfma_f32_16x16x32_bf16 v[180:183], v[68:71], v[92:95], v[180:183]
    ds_read_b64_tr_b16 v[18:19], v118 offset:2048
    v_mfma_f32_16x16x32_bf16 v[184:187], v[68:71], v[96:99], v[184:187]
    ds_read_b64_tr_b16 v[20:21], v119 offset:0
    v_mfma_f32_16x16x32_bf16 v[188:191], v[68:71], v[100:103], v[188:191]
    ds_read_b64_tr_b16 v[22:23], v119 offset:2048
    v_mfma_f32_16x16x32_bf16 v[192:195], v[72:75], v[88:91], v[192:195]
    ds_read_b64_tr_b16 v[24:25], v116 offset:4096
    v_mfma_f32_16x16x32_bf16 v[196:199], v[72:75], v[92:95], v[196:199]
    ds_read_b64_tr_b16 v[26:27], v116 offset:6144
    v_mfma_f32_16x16x32_bf16 v[200:203], v[72:75], v[96:99], v[200:203]
    ds_read_b64_tr_b16 v[28:29], v117 offset:4096
    v_mfma_f32_16x16x32_bf16 v[204:207], v[72:75], v[100:103], v[204:207]
    ds_read_b64_tr_b16 v[30:31], v117 offset:6144
    v_mfma_f32_16x16x32_bf16 v[208:211], v[76:79], v[88:91], v[208:211]
    ds_read_b64_tr_b16 v[32:33], v118 offset:4096
    v_mfma_f32_16x16x32_bf16 v[212:215], v[76:79], v[92:95], v[212:215]
    ds_read_b64_tr_b16 v[34:35], v118 offset:6144
    v_mfma_f32_16x16x32_bf16 v[216:219], v[76:79], v[96:99], v[216:219]
    ds_read_b64_tr_b16 v[36:37], v119 offset:4096
    v_mfma_f32_16x16x32_bf16 v[220:223], v[76:79], v[100:103], v[220:223]
    ds_read_b64_tr_b16 v[38:39], v119 offset:6144
    v_mfma_f32_16x16x32_bf16 v[224:227], v[80:83], v[88:91], v[224:227]
    v_mfma_f32_16x16x32_bf16 v[228:231], v[80:83], v[92:95], v[228:231]
    v_mfma_f32_16x16x32_bf16 v[232:235], v[80:83], v[96:99], v[232:235]
    v_mfma_f32_16x16x32_bf16 v[236:239], v[80:83], v[100:103], v[236:239]
    v_mfma_f32_16x16x32_bf16 v[240:243], v[84:87], v[88:91], v[240:243]
    v_mfma_f32_16x16x32_bf16 v[244:247], v[84:87], v[92:95], v[244:247]
    v_mfma_f32_16x16x32_bf16 v[248:251], v[84:87], v[96:99], v[248:251]
    v_mfma_f32_16x16x32_bf16 v[252:255], v[84:87], v[100:103], v[252:255]
    s_waitcnt lgkmcnt(0)
    s_barrier
    v_lshrrev_b32 v4, 4, v2
    v_lshlrev_b32 v4, 4, v4
    v_add_u32 v4, 147456, v4
    v_and_b32 v5, 15, v2
    s_lshl_b32 s51, s48, 9
    s_add_u32 s51, s51, 147968
    v_lshl_add_u32 v5, v5, 3, s51
    v_mfma_f32_16x16x32_bf16 v[128:131], v[8:11], v[40:43], v[128:131]
    ds_read_b64_tr_b16 v[88:89], v104 offset:24576
    ds_read_b64_tr_b16 v[90:91], v104 offset:32768
    v_mfma_f32_16x16x32_bf16 v[132:135], v[8:11], v[44:47], v[132:135]
    ds_read_b64_tr_b16 v[92:93], v105 offset:24576
    ds_read_b64_tr_b16 v[94:95], v105 offset:32768
    v_mfma_f32_16x16x32_bf16 v[136:139], v[8:11], v[48:51], v[136:139]
    ds_read_b64_tr_b16 v[96:97], v106 offset:24576
    ds_read_b64_tr_b16 v[98:99], v106 offset:32768
    v_mfma_f32_16x16x32_bf16 v[140:143], v[8:11], v[52:55], v[140:143]
    ds_read_b64_tr_b16 v[100:101], v107 offset:24576
    ds_read_b64_tr_b16 v[102:103], v107 offset:32768
    v_mfma_f32_16x16x32_bf16 v[144:147], v[12:15], v[40:43], v[144:147]
    ds_read_b64_tr_b16 v[56:57], v116 offset:24576
    ds_read_b64_tr_b16 v[58:59], v116 offset:26624
    v_mfma_f32_16x16x32_bf16 v[148:151], v[12:15], v[44:47], v[148:151]
    ds_read_b64_tr_b16 v[60:61], v117 offset:24576
    ds_read_b64_tr_b16 v[62:63], v117 offset:26624
    v_mfma_f32_16x16x32_bf16 v[152:155], v[12:15], v[48:51], v[152:155]
    ds_read_b64_tr_b16 v[72:73], v116 offset:28672
    ds_read_b64_tr_b16 v[74:75], v116 offset:30720
    v_mfma_f32_16x16x32_bf16 v[156:159], v[12:15], v[52:55], v[156:159]
    ds_read_b64_tr_b16 v[76:77], v117 offset:28672
    ds_read_b64_tr_b16 v[78:79], v117 offset:30720
    v_mfma_f32_16x16x32_bf16 v[192:195], v[24:27], v[40:43], v[192:195]
    ds_read_b64_tr_b16 v[64:65], v118 offset:24576
    ds_read_b64_tr_b16 v[66:67], v118 offset:26624
    v_mfma_f32_16x16x32_bf16 v[196:199], v[24:27], v[44:47], v[196:199]
    ds_read_b64_tr_b16 v[68:69], v119 offset:24576
    ds_read_b64_tr_b16 v[70:71], v119 offset:26624
    v_mfma_f32_16x16x32_bf16 v[200:203], v[24:27], v[48:51], v[200:203]
    ds_read_b64_tr_b16 v[80:81], v118 offset:28672
    ds_read_b64_tr_b16 v[82:83], v118 offset:30720
    v_mfma_f32_16x16x32_bf16 v[204:207], v[24:27], v[52:55], v[204:207]
    ds_read_b64_tr_b16 v[84:85], v119 offset:28672
    ds_read_b64_tr_b16 v[86:87], v119 offset:30720
    v_mfma_f32_16x16x32_bf16 v[208:211], v[28:31], v[40:43], v[208:211]
    v_mfma_f32_16x16x32_bf16 v[212:215], v[28:31], v[44:47], v[212:215]
    v_mfma_f32_16x16x32_bf16 v[216:219], v[28:31], v[48:51], v[216:219]
    v_mfma_f32_16x16x32_bf16 v[220:223], v[28:31], v[52:55], v[220:223]
    s_lshl_b32 s51, s50, 4
    s_lshl_b32 s52, s48, 2
    s_add_u32 s51, s51, s52
    s_mul_i32 s51, s51, 57344
    s_lshl_b32 s52, s49, 11
    s_add_u32 s51, s51, s52
    s_add_u32 s51, s51, 4194304
    v_lshlrev_b32_e64 v6, 4, v2
    s_waitcnt lgkmcnt(0)
    v_mfma_f32_16x16x32_bf16 v[128:131], v[56:59], v[88:91], v[128:131]
    ds_read_b128 v[104:107], v4 offset:0
    v_mfma_f32_16x16x32_bf16 v[144:147], v[60:63], v[88:91], v[144:147]
    ds_read_b128 v[108:111], v4 offset:64
    v_mfma_f32_16x16x32_bf16 v[192:195], v[72:75], v[88:91], v[192:195]
    ds_read_b128 v[112:115], v4 offset:256
    v_mfma_f32_16x16x32_bf16 v[208:211], v[76:79], v[88:91], v[208:211]
    ds_read_b128 v[116:119], v4 offset:320
    v_mfma_f32_16x16x32_bf16 v[132:135], v[56:59], v[92:95], v[132:135]
    ds_read_b64 v[120:121], v5 offset:0
    v_mfma_f32_16x16x32_bf16 v[148:151], v[60:63], v[92:95], v[148:151]
    ds_read_b64 v[122:123], v5 offset:128
    v_mfma_f32_16x16x32_bf16 v[196:199], v[72:75], v[92:95], v[196:199]
    ds_read_b64 v[124:125], v5 offset:256
    v_mfma_f32_16x16x32_bf16 v[212:215], v[76:79], v[92:95], v[212:215]
    ds_read_b64 v[126:127], v5 offset:384
    v_mfma_f32_16x16x32_bf16 v[136:139], v[56:59], v[96:99], v[136:139]
    v_mfma_f32_16x16x32_bf16 v[152:155], v[60:63], v[96:99], v[152:155]
    v_mfma_f32_16x16x32_bf16 v[200:203], v[72:75], v[96:99], v[200:203]
    v_mfma_f32_16x16x32_bf16 v[216:219], v[76:79], v[96:99], v[216:219]
    v_mfma_f32_16x16x32_bf16 v[140:143], v[56:59], v[100:103], v[140:143]
    v_mfma_f32_16x16x32_bf16 v[156:159], v[60:63], v[100:103], v[156:159]
    v_mfma_f32_16x16x32_bf16 v[204:207], v[72:75], v[100:103], v[204:207]
    v_mfma_f32_16x16x32_bf16 v[220:223], v[76:79], v[100:103], v[220:223]
    s_waitcnt lgkmcnt(0)
    s_nop 0
    v_mfma_f32_16x16x32_bf16 v[160:163], v[16:19], v[40:43], v[160:163]
    v_pk_fma_f32 v[128:129], v[104:105], v[120:121], v[128:129] op_sel:[0,0,0] op_sel_hi:[1,0,1]
    v_pk_fma_f32 v[130:131], v[106:107], v[120:121], v[130:131] op_sel:[0,0,0] op_sel_hi:[1,0,1]
    v_mfma_f32_16x16x32_bf16 v[164:167], v[16:19], v[44:47], v[164:167]
    v_pk_fma_f32 v[144:145], v[108:109], v[120:121], v[144:145] op_sel:[0,0,0] op_sel_hi:[1,0,1]
    v_pk_fma_f32 v[146:147], v[110:111], v[120:121], v[146:147] op_sel:[0,0,0] op_sel_hi:[1,0,1]
    v_mfma_f32_16x16x32_bf16 v[168:171], v[16:19], v[48:51], v[168:171]
    v_pk_fma_f32 v[192:193], v[112:113], v[120:121], v[192:193] op_sel:[0,0,0] op_sel_hi:[1,0,1]
    v_pk_fma_f32 v[194:195], v[114:115], v[120:121], v[194:195] op_sel:[0,0,0] op_sel_hi:[1,0,1]
    v_mfma_f32_16x16x32_bf16 v[172:175], v[16:19], v[52:55], v[172:175]
    v_pk_fma_f32 v[208:209], v[116:117], v[120:121], v[208:209] op_sel:[0,0,0] op_sel_hi:[1,0,1]
    v_pk_fma_f32 v[210:211], v[118:119], v[120:121], v[210:211] op_sel:[0,0,0] op_sel_hi:[1,0,1]
    v_mfma_f32_16x16x32_bf16 v[176:179], v[20:23], v[40:43], v[176:179]
    v_max_f32 v128, 0, v128
    v_max_f32 v129, 0, v129
    v_mfma_f32_16x16x32_bf16 v[180:183], v[20:23], v[44:47], v[180:183]
    v_max_f32 v130, 0, v130
    v_max_f32 v131, 0, v131
    v_mfma_f32_16x16x32_bf16 v[184:187], v[20:23], v[48:51], v[184:187]
    v_max_f32 v144, 0, v144
    v_max_f32 v145, 0, v145
    v_mfma_f32_16x16x32_bf16 v[188:191], v[20:23], v[52:55], v[188:191]
    v_max_f32 v146, 0, v146
    v_max_f32 v147, 0, v147
    v_mfma_f32_16x16x32_bf16 v[224:227], v[32:35], v[40:43], v[224:227]
    v_pk_mul_f32 v[128:129], v[128:129], v[192:193]
    v_pk_mul_f32 v[130:131], v[130:131], v[194:195]
    v_mfma_f32_16x16x32_bf16 v[228:231], v[32:35], v[44:47], v[228:231]
    v_pk_mul_f32 v[144:145], v[144:145], v[208:209]
    v_pk_mul_f32 v[146:147], v[146:147], v[210:211]
    v_mfma_f32_16x16x32_bf16 v[232:235], v[32:35], v[48:51], v[232:235]
    v_cvt_pk_bf16_f32 v192, v128, v129
    v_cvt_pk_bf16_f32 v193, v130, v131
    v_mfma_f32_16x16x32_bf16 v[236:239], v[32:35], v[52:55], v[236:239]
    v_cvt_pk_bf16_f32 v194, v144, v145
    v_cvt_pk_bf16_f32 v195, v146, v147
    v_mfma_f32_16x16x32_bf16 v[240:243], v[36:39], v[40:43], v[240:243]
    s_add_u32 s52, s51, 0
    s_nop 0
    buffer_store_dwordx4 v[192:195], v6, s[56:59], s52 offen sc1
    v_mfma_f32_16x16x32_bf16 v[244:247], v[36:39], v[44:47], v[244:247]
    v_pk_fma_f32 v[132:133], v[104:105], v[122:123], v[132:133] op_sel:[0,0,0] op_sel_hi:[1,0,1]
    v_pk_fma_f32 v[134:135], v[106:107], v[122:123], v[134:135] op_sel:[0,0,0] op_sel_hi:[1,0,1]
    v_mfma_f32_16x16x32_bf16 v[248:251], v[36:39], v[48:51], v[248:251]
    v_pk_fma_f32 v[148:149], v[108:109], v[122:123], v[148:149] op_sel:[0,0,0] op_sel_hi:[1,0,1]
    v_pk_fma_f32 v[150:151], v[110:111], v[122:123], v[150:151] op_sel:[0,0,0] op_sel_hi:[1,0,1]
    v_mfma_f32_16x16x32_bf16 v[252:255], v[36:39], v[52:55], v[252:255]
    v_pk_fma_f32 v[196:197], v[112:113], v[122:123], v[196:197] op_sel:[0,0,0] op_sel_hi:[1,0,1]
    v_pk_fma_f32 v[198:199], v[114:115], v[122:123], v[198:199] op_sel:[0,0,0] op_sel_hi:[1,0,1]
    v_mfma_f32_16x16x32_bf16 v[160:163], v[64:67], v[88:91], v[160:163]
    v_pk_fma_f32 v[212:213], v[116:117], v[122:123], v[212:213] op_sel:[0,0,0] op_sel_hi:[1,0,1]
    v_pk_fma_f32 v[214:215], v[118:119], v[122:123], v[214:215] op_sel:[0,0,0] op_sel_hi:[1,0,1]
    v_mfma_f32_16x16x32_bf16 v[176:179], v[68:71], v[88:91], v[176:179]
    v_max_f32 v132, 0, v132
    v_max_f32 v133, 0, v133
    v_mfma_f32_16x16x32_bf16 v[224:227], v[80:83], v[88:91], v[224:227]
    v_max_f32 v134, 0, v134
    v_max_f32 v135, 0, v135
    v_mfma_f32_16x16x32_bf16 v[240:243], v[84:87], v[88:91], v[240:243]
    v_max_f32 v148, 0, v148
    v_max_f32 v149, 0, v149
    v_mfma_f32_16x16x32_bf16 v[164:167], v[64:67], v[92:95], v[164:167]
    v_max_f32 v150, 0, v150
    v_max_f32 v151, 0, v151
    v_mfma_f32_16x16x32_bf16 v[180:183], v[68:71], v[92:95], v[180:183]
    v_pk_mul_f32 v[132:133], v[132:133], v[196:197]
    v_pk_mul_f32 v[134:135], v[134:135], v[198:199]
    v_mfma_f32_16x16x32_bf16 v[228:231], v[80:83], v[92:95], v[228:231]
    v_pk_mul_f32 v[148:149], v[148:149], v[212:213]
    v_pk_mul_f32 v[150:151], v[150:151], v[214:215]
    v_mfma_f32_16x16x32_bf16 v[244:247], v[84:87], v[92:95], v[244:247]
    v_cvt_pk_bf16_f32 v196, v132, v133
    v_cvt_pk_bf16_f32 v197, v134, v135
    v_mfma_f32_16x16x32_bf16 v[168:171], v[64:67], v[96:99], v[168:171]
    v_cvt_pk_bf16_f32 v198, v148, v149
    v_cvt_pk_bf16_f32 v199, v150, v151
    v_mfma_f32_16x16x32_bf16 v[184:187], v[68:71], v[96:99], v[184:187]
    s_add_u32 s52, s51, 57344
    buffer_store_dwordx4 v[196:199], v6, s[56:59], s52 offen sc1
    v_mfma_f32_16x16x32_bf16 v[232:235], v[80:83], v[96:99], v[232:235]
    v_pk_fma_f32 v[136:137], v[104:105], v[124:125], v[136:137] op_sel:[0,0,0] op_sel_hi:[1,0,1]
    v_pk_fma_f32 v[138:139], v[106:107], v[124:125], v[138:139] op_sel:[0,0,0] op_sel_hi:[1,0,1]
    v_mfma_f32_16x16x32_bf16 v[248:251], v[84:87], v[96:99], v[248:251]
    v_pk_fma_f32 v[152:153], v[108:109], v[124:125], v[152:153] op_sel:[0,0,0] op_sel_hi:[1,0,1]
    v_pk_fma_f32 v[154:155], v[110:111], v[124:125], v[154:155] op_sel:[0,0,0] op_sel_hi:[1,0,1]
    v_mfma_f32_16x16x32_bf16 v[172:175], v[64:67], v[100:103], v[172:175]
    v_pk_fma_f32 v[200:201], v[112:113], v[124:125], v[200:201] op_sel:[0,0,0] op_sel_hi:[1,0,1]
    v_pk_fma_f32 v[202:203], v[114:115], v[124:125], v[202:203] op_sel:[0,0,0] op_sel_hi:[1,0,1]
    v_mfma_f32_16x16x32_bf16 v[188:191], v[68:71], v[100:103], v[188:191]
    v_pk_fma_f32 v[216:217], v[116:117], v[124:125], v[216:217] op_sel:[0,0,0] op_sel_hi:[1,0,1]
    v_pk_fma_f32 v[218:219], v[118:119], v[124:125], v[218:219] op_sel:[0,0,0] op_sel_hi:[1,0,1]
    v_mfma_f32_16x16x32_bf16 v[236:239], v[80:83], v[100:103], v[236:239]
    v_max_f32 v136, 0, v136
    v_max_f32 v137, 0, v137
    v_mfma_f32_16x16x32_bf16 v[252:255], v[84:87], v[100:103], v[252:255]
    v_max_f32 v138, 0, v138
    v_max_f32 v139, 0, v139
    v_max_f32 v152, 0, v152
    v_max_f32 v153, 0, v153
    v_max_f32 v154, 0, v154
    v_max_f32 v155, 0, v155
    v_pk_mul_f32 v[136:137], v[136:137], v[200:201]
    v_pk_mul_f32 v[138:139], v[138:139], v[202:203]
    v_pk_mul_f32 v[152:153], v[152:153], v[216:217]
    v_pk_mul_f32 v[154:155], v[154:155], v[218:219]
    v_cvt_pk_bf16_f32 v200, v136, v137
    v_cvt_pk_bf16_f32 v201, v138, v139
    v_cvt_pk_bf16_f32 v202, v152, v153
    v_cvt_pk_bf16_f32 v203, v154, v155
    s_add_u32 s52, s51, 114688
    buffer_store_dwordx4 v[200:203], v6, s[56:59], s52 offen sc1
    v_pk_fma_f32 v[140:141], v[104:105], v[126:127], v[140:141] op_sel:[0,0,0] op_sel_hi:[1,0,1]
    v_pk_fma_f32 v[142:143], v[106:107], v[126:127], v[142:143] op_sel:[0,0,0] op_sel_hi:[1,0,1]
    v_pk_fma_f32 v[156:157], v[108:109], v[126:127], v[156:157] op_sel:[0,0,0] op_sel_hi:[1,0,1]
    v_pk_fma_f32 v[158:159], v[110:111], v[126:127], v[158:159] op_sel:[0,0,0] op_sel_hi:[1,0,1]
    v_pk_fma_f32 v[204:205], v[112:113], v[126:127], v[204:205] op_sel:[0,0,0] op_sel_hi:[1,0,1]
    v_pk_fma_f32 v[206:207], v[114:115], v[126:127], v[206:207] op_sel:[0,0,0] op_sel_hi:[1,0,1]
    v_pk_fma_f32 v[220:221], v[116:117], v[126:127], v[220:221] op_sel:[0,0,0] op_sel_hi:[1,0,1]
    v_pk_fma_f32 v[222:223], v[118:119], v[126:127], v[222:223] op_sel:[0,0,0] op_sel_hi:[1,0,1]
    v_max_f32 v140, 0, v140
    v_max_f32 v141, 0, v141
    v_max_f32 v142, 0, v142
    v_max_f32 v143, 0, v143
    v_max_f32 v156, 0, v156
    v_max_f32 v157, 0, v157
    v_max_f32 v158, 0, v158
    v_max_f32 v159, 0, v159
    v_pk_mul_f32 v[140:141], v[140:141], v[204:205]
    v_pk_mul_f32 v[142:143], v[142:143], v[206:207]
    v_pk_mul_f32 v[156:157], v[156:157], v[220:221]
    v_pk_mul_f32 v[158:159], v[158:159], v[222:223]
    v_cvt_pk_bf16_f32 v204, v140, v141
    v_cvt_pk_bf16_f32 v205, v142, v143
    v_cvt_pk_bf16_f32 v206, v156, v157
    v_cvt_pk_bf16_f32 v207, v158, v159
    s_add_u32 s52, s51, 172032
    buffer_store_dwordx4 v[204:207], v6, s[56:59], s52 offen sc1
    ds_read_b128 v[104:107], v4 offset:128
    ds_read_b128 v[108:111], v4 offset:192
    ds_read_b128 v[112:115], v4 offset:384
    ds_read_b128 v[116:119], v4 offset:448
    s_waitcnt lgkmcnt(0)
    s_nop 0
    v_pk_fma_f32 v[160:161], v[104:105], v[120:121], v[160:161] op_sel:[0,0,0] op_sel_hi:[1,0,1]
    v_pk_fma_f32 v[162:163], v[106:107], v[120:121], v[162:163] op_sel:[0,0,0] op_sel_hi:[1,0,1]
    v_pk_fma_f32 v[176:177], v[108:109], v[120:121], v[176:177] op_sel:[0,0,0] op_sel_hi:[1,0,1]
    v_pk_fma_f32 v[178:179], v[110:111], v[120:121], v[178:179] op_sel:[0,0,0] op_sel_hi:[1,0,1]
    v_pk_fma_f32 v[224:225], v[112:113], v[120:121], v[224:225] op_sel:[0,0,0] op_sel_hi:[1,0,1]
    v_pk_fma_f32 v[226:227], v[114:115], v[120:121], v[226:227] op_sel:[0,0,0] op_sel_hi:[1,0,1]
    v_pk_fma_f32 v[240:241], v[116:117], v[120:121], v[240:241] op_sel:[0,0,0] op_sel_hi:[1,0,1]
    v_pk_fma_f32 v[242:243], v[118:119], v[120:121], v[242:243] op_sel:[0,0,0] op_sel_hi:[1,0,1]
    v_max_f32 v160, 0, v160
    v_max_f32 v161, 0, v161
    v_max_f32 v162, 0, v162
    v_max_f32 v163, 0, v163
    v_max_f32 v176, 0, v176
    v_max_f32 v177, 0, v177
    v_max_f32 v178, 0, v178
    v_max_f32 v179, 0, v179
    v_pk_mul_f32 v[160:161], v[160:161], v[224:225]
    v_pk_mul_f32 v[162:163], v[162:163], v[226:227]
    v_pk_mul_f32 v[176:177], v[176:177], v[240:241]
    v_pk_mul_f32 v[178:179], v[178:179], v[242:243]
    v_cvt_pk_bf16_f32 v224, v160, v161
    v_cvt_pk_bf16_f32 v225, v162, v163
    v_cvt_pk_bf16_f32 v226, v176, v177
    v_cvt_pk_bf16_f32 v227, v178, v179
    s_add_u32 s52, s51, 1024
    buffer_store_dwordx4 v[224:227], v6, s[56:59], s52 offen sc1
    v_pk_fma_f32 v[164:165], v[104:105], v[122:123], v[164:165] op_sel:[0,0,0] op_sel_hi:[1,0,1]
    v_pk_fma_f32 v[166:167], v[106:107], v[122:123], v[166:167] op_sel:[0,0,0] op_sel_hi:[1,0,1]
    v_pk_fma_f32 v[180:181], v[108:109], v[122:123], v[180:181] op_sel:[0,0,0] op_sel_hi:[1,0,1]
    v_pk_fma_f32 v[182:183], v[110:111], v[122:123], v[182:183] op_sel:[0,0,0] op_sel_hi:[1,0,1]
    v_pk_fma_f32 v[228:229], v[112:113], v[122:123], v[228:229] op_sel:[0,0,0] op_sel_hi:[1,0,1]
    v_pk_fma_f32 v[230:231], v[114:115], v[122:123], v[230:231] op_sel:[0,0,0] op_sel_hi:[1,0,1]
    v_pk_fma_f32 v[244:245], v[116:117], v[122:123], v[244:245] op_sel:[0,0,0] op_sel_hi:[1,0,1]
    v_pk_fma_f32 v[246:247], v[118:119], v[122:123], v[246:247] op_sel:[0,0,0] op_sel_hi:[1,0,1]
    v_max_f32 v164, 0, v164
    v_max_f32 v165, 0, v165
    v_max_f32 v166, 0, v166
    v_max_f32 v167, 0, v167
    v_max_f32 v180, 0, v180
    v_max_f32 v181, 0, v181
    v_max_f32 v182, 0, v182
    v_max_f32 v183, 0, v183
    v_pk_mul_f32 v[164:165], v[164:165], v[228:229]
    v_pk_mul_f32 v[166:167], v[166:167], v[230:231]
    v_pk_mul_f32 v[180:181], v[180:181], v[244:245]
    v_pk_mul_f32 v[182:183], v[182:183], v[246:247]
    v_cvt_pk_bf16_f32 v228, v164, v165
    v_cvt_pk_bf16_f32 v229, v166, v167
    v_cvt_pk_bf16_f32 v230, v180, v181
    v_cvt_pk_bf16_f32 v231, v182, v183
    s_add_u32 s52, s51, 58368
    buffer_store_dwordx4 v[228:231], v6, s[56:59], s52 offen sc1
    v_pk_fma_f32 v[168:169], v[104:105], v[124:125], v[168:169] op_sel:[0,0,0] op_sel_hi:[1,0,1]
    v_pk_fma_f32 v[170:171], v[106:107], v[124:125], v[170:171] op_sel:[0,0,0] op_sel_hi:[1,0,1]
    v_pk_fma_f32 v[184:185], v[108:109], v[124:125], v[184:185] op_sel:[0,0,0] op_sel_hi:[1,0,1]
    v_pk_fma_f32 v[186:187], v[110:111], v[124:125], v[186:187] op_sel:[0,0,0] op_sel_hi:[1,0,1]
    v_pk_fma_f32 v[232:233], v[112:113], v[124:125], v[232:233] op_sel:[0,0,0] op_sel_hi:[1,0,1]
    v_pk_fma_f32 v[234:235], v[114:115], v[124:125], v[234:235] op_sel:[0,0,0] op_sel_hi:[1,0,1]
    v_pk_fma_f32 v[248:249], v[116:117], v[124:125], v[248:249] op_sel:[0,0,0] op_sel_hi:[1,0,1]
    v_pk_fma_f32 v[250:251], v[118:119], v[124:125], v[250:251] op_sel:[0,0,0] op_sel_hi:[1,0,1]
    v_max_f32 v168, 0, v168
    v_max_f32 v169, 0, v169
    v_max_f32 v170, 0, v170
    v_max_f32 v171, 0, v171
    v_max_f32 v184, 0, v184
    v_max_f32 v185, 0, v185
    v_max_f32 v186, 0, v186
    v_max_f32 v187, 0, v187
    v_pk_mul_f32 v[168:169], v[168:169], v[232:233]
    v_pk_mul_f32 v[170:171], v[170:171], v[234:235]
    v_pk_mul_f32 v[184:185], v[184:185], v[248:249]
    v_pk_mul_f32 v[186:187], v[186:187], v[250:251]
    v_cvt_pk_bf16_f32 v232, v168, v169
    v_cvt_pk_bf16_f32 v233, v170, v171
    v_cvt_pk_bf16_f32 v234, v184, v185
    v_cvt_pk_bf16_f32 v235, v186, v187
    s_add_u32 s52, s51, 115712
    buffer_store_dwordx4 v[232:235], v6, s[56:59], s52 offen sc1
    v_pk_fma_f32 v[172:173], v[104:105], v[126:127], v[172:173] op_sel:[0,0,0] op_sel_hi:[1,0,1]
    v_pk_fma_f32 v[174:175], v[106:107], v[126:127], v[174:175] op_sel:[0,0,0] op_sel_hi:[1,0,1]
    v_pk_fma_f32 v[188:189], v[108:109], v[126:127], v[188:189] op_sel:[0,0,0] op_sel_hi:[1,0,1]
    v_pk_fma_f32 v[190:191], v[110:111], v[126:127], v[190:191] op_sel:[0,0,0] op_sel_hi:[1,0,1]
    v_pk_fma_f32 v[236:237], v[112:113], v[126:127], v[236:237] op_sel:[0,0,0] op_sel_hi:[1,0,1]
    v_pk_fma_f32 v[238:239], v[114:115], v[126:127], v[238:239] op_sel:[0,0,0] op_sel_hi:[1,0,1]
    v_pk_fma_f32 v[252:253], v[116:117], v[126:127], v[252:253] op_sel:[0,0,0] op_sel_hi:[1,0,1]
    v_pk_fma_f32 v[254:255], v[118:119], v[126:127], v[254:255] op_sel:[0,0,0] op_sel_hi:[1,0,1]
    v_max_f32 v172, 0, v172
    v_max_f32 v173, 0, v173
    v_max_f32 v174, 0, v174
    v_max_f32 v175, 0, v175
    v_max_f32 v188, 0, v188
    v_max_f32 v189, 0, v189
    v_max_f32 v190, 0, v190
    v_max_f32 v191, 0, v191
    v_pk_mul_f32 v[172:173], v[172:173], v[236:237]
    v_pk_mul_f32 v[174:175], v[174:175], v[238:239]
    v_pk_mul_f32 v[188:189], v[188:189], v[252:253]
    v_pk_mul_f32 v[190:191], v[190:191], v[254:255]
    v_cvt_pk_bf16_f32 v236, v172, v173
    v_cvt_pk_bf16_f32 v237, v174, v175
    v_cvt_pk_bf16_f32 v238, v188, v189
    v_cvt_pk_bf16_f32 v239, v190, v191
    s_add_u32 s52, s51, 173056
    buffer_store_dwordx4 v[236:239], v6, s[56:59], s52 offen sc1
    s_lshl_b32 s51, s48, 10
    v_lshl_add_u32 v4, v2, 4, s51
    v_add_u32 v5, 65536, v4
    v_add_u32 v6, 131072, v4
    s_barrier
    ds_read_b128 v[8:11], v5 offset:32768
    ds_read_b128 v[12:15], v5 offset:36864
    ds_read_b128 v[16:19], v5 offset:40960
    ds_read_b128 v[20:23], v5 offset:45056
    ds_read_b128 v[24:27], v5 offset:49152
    ds_read_b128 v[28:31], v5 offset:53248
    ds_read_b128 v[32:35], v5 offset:57344
    ds_read_b128 v[36:39], v5 offset:61440
    ds_read_b128 v[40:43], v6 offset:0
    ds_read_b128 v[44:47], v6 offset:4096
    ds_read_b128 v[48:51], v6 offset:8192
    ds_read_b128 v[52:55], v6 offset:12288
    ds_read_b128 v[56:59], v4 offset:49152
    ds_read_b128 v[60:63], v4 offset:53248
    ds_read_b128 v[64:67], v4 offset:57344
    ds_read_b128 v[68:71], v4 offset:61440
    ds_read_b128 v[72:75], v5 offset:0
    ds_read_b128 v[76:79], v5 offset:4096
    ds_read_b128 v[80:83], v5 offset:8192
    ds_read_b128 v[84:87], v5 offset:12288
    ds_read_b128 v[88:91], v5 offset:16384
    ds_read_b128 v[92:95], v5 offset:20480
    ds_read_b128 v[96:99], v5 offset:24576
    ds_read_b128 v[100:103], v5 offset:28672
    ds_read_b128 v[104:107], v4 offset:0
    ds_read_b128 v[108:111], v4 offset:4096
    ds_read_b128 v[112:115], v4 offset:8192
    ds_read_b128 v[116:119], v4 offset:12288
    s_lshl_b32 s51, s50, 2
    s_add_u32 s51, s51, s48
    s_mul_i32 s51, s51, 28
    s_add_u32 s51, s51, s49
    s_lshl_b32 s51, s51, 7
    s_add_u32 s51, s51, 11796480
    v_mov_b32 v120, s51
    v_mov_b32_e64 v121, s55
    s_mov_b64 exec, 1
    s_waitcnt vmcnt(0)
    buffer_store_dword v121, v120, s[56:59], 0 offen sc1
    s_mov_b64 exec, -1
    s_setprio 0
    s_branch L_k2_sync
L_k2_load:
    s_sub_u32 s54, s48, 4
    v_lshrrev_b32_e64 v4, 5, v2
    v_bfe_u32 v5, v2, 1, 4
    v_and_b32 v6, 1, v2
    s_lshl_b32 s51, s54, 15
    s_lshl_b32 s52, s50, 9
    s_add_u32 s51, s51, s52
    s_add_u32 s51, s51, 65536
    v_add_u32 v7, 0, v4
    v_xor_b32 v125, v7, v5
    v_lshlrev_b32_e64 v125, 5, v125
    v_lshl_add_u32 v125, v6, 4, v125
    v_lshl_add_u32 v125, v7, 12, v125
    v_add_u32 v120, s51, v125
    v_add_u32 v7, 2, v4
    v_xor_b32 v125, v7, v5
    v_lshlrev_b32 v125, 5, v125
    v_lshl_add_u32 v125, v6, 4, v125
    v_lshl_add_u32 v125, v7, 12, v125
    v_add_u32 v121, s51, v125
    v_add_u32 v7, 4, v4
    v_xor_b32 v125, v7, v5
    v_lshlrev_b32 v125, 5, v125
    v_lshl_add_u32 v125, v6, 4, v125
    v_lshl_add_u32 v125, v7, 12, v125
    v_add_u32 v122, s51, v125
    v_add_u32 v7, 6, v4
    v_xor_b32 v125, v7, v5
    v_lshlrev_b32 v125, 5, v125
    v_lshl_add_u32 v125, v6, 4, v125
    v_lshl_add_u32 v125, v7, 12, v125
    v_add_u32 v123, s51, v125
    v_lshrrev_b32 v4, 3, v2
    v_bfe_u32 v5, v2, 1, 2
    v_lshrrev_b32 v7, 1, v4
    v_xor_b32 v5, v5, v7
    v_lshlrev_b32_e64 v5, 5, v5
    v_lshl_add_u32 v5, v6, 4, v5
    v_mul_u32_u24 v4, 3584, v4
    s_mul_i32 s51, s54, 28672
    s_lshl_b32 s52, s49, 7
    s_add_u32 s51, s51, s52
    v_add3_u32 v124, v4, v5, s51
    s_lshl_b32 s74, s54, 12
    s_lshl_b32 s75, s54, 10
    s_waitcnt lgkmcnt(0)
    s_load_dword s55, s[46:47], 0
    s_mov_b32 s56, s46
    s_mov_b32 s57, s47
    s_mov_b32 s60, s36
    s_mov_b32 s61, s37
    s_mov_b32 s64, s38
    s_mov_b32 s65, s39
    s_mov_b32 s52, 0
    s_add_u32 m0, s75, 16384
    s_nop 0
    buffer_load_dwordx4 v124, s[60:63], s52 offen lds
    s_mov_b32 s52, 0
    s_add_u32 m0, s75, 20480
    s_nop 0
    buffer_load_dwordx4 v124, s[64:67], s52 offen lds
    s_mov_b32 s52, 0
    s_add_u32 m0, s74, 0
    s_nop 0
    buffer_load_dwordx4 v120, s[56:59], s52 offen lds
    s_mov_b32 s52, 0
    s_add_u32 m0, s74, 1024
    s_nop 0
    buffer_load_dwordx4 v121, s[56:59], s52 offen lds
    s_mov_b32 s52, 0
    s_add_u32 m0, s74, 2048
    s_nop 0
    buffer_load_dwordx4 v122, s[56:59], s52 offen lds
    s_mov_b32 s52, 0
    s_add_u32 m0, s74, 3072
    s_nop 0
    buffer_load_dwordx4 v123, s[56:59], s52 offen lds
    s_mov_b32 s52, 114688
    s_add_u32 m0, s75, 40960
    s_nop 0
    buffer_load_dwordx4 v124, s[60:63], s52 offen lds
    s_mov_b32 s52, 114688
    s_add_u32 m0, s75, 45056
    s_nop 0
    buffer_load_dwordx4 v124, s[64:67], s52 offen lds
    s_mov_b32 s52, 131072
    s_add_u32 m0, s74, 24576
    s_nop 0
    buffer_load_dwordx4 v120, s[56:59], s52 offen lds
    s_mov_b32 s52, 131072
    s_add_u32 m0, s74, 25600
    s_nop 0
    buffer_load_dwordx4 v121, s[56:59], s52 offen lds
    s_mov_b32 s52, 131072
    s_add_u32 m0, s74, 26624
    s_nop 0
    buffer_load_dwordx4 v122, s[56:59], s52 offen lds
    s_mov_b32 s52, 131072
    s_add_u32 m0, s74, 27648
    s_nop 0
    buffer_load_dwordx4 v123, s[56:59], s52 offen lds
    s_lshr_b32 s51, s78, 2
    s_mul_i32 s72, s51, 229376
    s_add_u32 s72, s72, 2097152
    s_and_b32 s51, s78, 3
    s_lshl_b32 s52, s77, 2
    s_add_u32 s51, s51, s52
    s_mul_i32 s73, s51, 229376
    s_add_u32 s73, s73, 4194304
    s_mul_i32 s79, s51, 28
    s_mul_i32 s51, s48, 7
    s_lshr_b32 s52, s51, 1
    s_add_u32 s79, s79, s52
    s_lshl_b32 s79, s79, 7
    s_add_u32 s79, s79, 11796480
    s_lshl_b32 s51, s51, 10
    v_lshl_add_u32 v3, v2, 4, s51
    s_mul_i32 s76, s54, 7168
    v_lshl_add_u32 v127, v2, 4, s76
    s_waitcnt vmcnt(6)
    s_barrier
    s_mov_b32 s52, 229376
    s_add_u32 m0, s75, 65536
    s_nop 0
    buffer_load_dwordx4 v124, s[60:63], s52 offen lds
    s_mov_b32 s52, 229376
    s_add_u32 m0, s75, 69632
    s_nop 0
    buffer_load_dwordx4 v124, s[64:67], s52 offen lds
    s_mov_b32 s52, 262144
    s_add_u32 m0, s74, 49152
    s_nop 0
    buffer_load_dwordx4 v120, s[56:59], s52 offen lds
    s_mov_b32 s52, 262144
    s_add_u32 m0, s74, 50176
    s_nop 0
    buffer_load_dwordx4 v121, s[56:59], s52 offen lds
    s_mov_b32 s52, 262144
    s_add_u32 m0, s74, 51200
    s_nop 0
    buffer_load_dwordx4 v122, s[56:59], s52 offen lds
    s_mov_b32 s52, 262144
    s_add_u32 m0, s74, 52224
    s_nop 0
    buffer_load_dwordx4 v123, s[56:59], s52 offen lds
    s_mov_b32 s52, 344064
    s_add_u32 m0, s75, 90112
    s_nop 0
    buffer_load_dwordx4 v124, s[60:63], s52 offen lds
    s_mov_b32 s52, 344064
    s_add_u32 m0, s75, 94208
    s_nop 0
    buffer_load_dwordx4 v124, s[64:67], s52 offen lds
    s_waitcnt vmcnt(8)
    s_barrier
    s_mov_b32 s52, 393216
    s_add_u32 m0, s74, 73728
    s_nop 0
    buffer_load_dwordx4 v120, s[56:59], s52 offen lds
    s_mov_b32 s52, 393216
    s_add_u32 m0, s74, 74752
    s_nop 0
    buffer_load_dwordx4 v121, s[56:59], s52 offen lds
    s_mov_b32 s52, 393216
    s_add_u32 m0, s74, 75776
    s_nop 0
    buffer_load_dwordx4 v122, s[56:59], s52 offen lds
    s_mov_b32 s52, 393216
    s_add_u32 m0, s74, 76800
    s_nop 0
    buffer_load_dwordx4 v123, s[56:59], s52 offen lds
    s_mov_b32 s52, 458752
    s_add_u32 m0, s75, 16384
    s_nop 0
    buffer_load_dwordx4 v124, s[60:63], s52 offen lds
    s_mov_b32 s52, 458752
    s_add_u32 m0, s75, 20480
    s_nop 0
    buffer_load_dwordx4 v124, s[64:67], s52 offen lds
    s_mov_b32 s52, 524288
    s_add_u32 m0, s74, 0
    s_nop 0
    buffer_load_dwordx4 v120, s[56:59], s52 offen lds
    s_mov_b32 s52, 524288
    s_add_u32 m0, s74, 1024
    s_nop 0
    buffer_load_dwordx4 v121, s[56:59], s52 offen lds
    s_waitcnt vmcnt(10)
    s_barrier
    s_mov_b32 s52, 524288
    s_add_u32 m0, s74, 2048
    s_nop 0
    buffer_load_dwordx4 v122, s[56:59], s52 offen lds
    s_mov_b32 s52, 524288
    s_add_u32 m0, s74, 3072
    s_nop 0
    buffer_load_dwordx4 v123, s[56:59], s52 offen lds
    s_mov_b32 s52, 573440
    s_add_u32 m0, s75, 40960
    s_nop 0
    buffer_load_dwordx4 v124, s[60:63], s52 offen lds
    s_mov_b32 s52, 573440
    s_add_u32 m0, s75, 45056
    s_nop 0
    buffer_load_dwordx4 v124, s[64:67], s52 offen lds
    s_mov_b32 s52, 655360
    s_add_u32 m0, s74, 24576
    s_nop 0
    buffer_load_dwordx4 v120, s[56:59], s52 offen lds
    s_mov_b32 s52, 655360
    s_add_u32 m0, s74, 25600
    s_nop 0
    buffer_load_dwordx4 v121, s[56:59], s52 offen lds
    s_mov_b32 s52, 655360
    s_add_u32 m0, s74, 26624
    s_nop 0
    buffer_load_dwordx4 v122, s[56:59], s52 offen lds
    s_mov_b32 s52, 655360
    s_add_u32 m0, s74, 27648
    s_nop 0
    buffer_load_dwordx4 v123, s[56:59], s52 offen lds
    s_waitcnt vmcnt(12)
    s_barrier
    s_mov_b32 s52, 688128
    s_add_u32 m0, s75, 65536
    s_nop 0
    buffer_load_dwordx4 v124, s[60:63], s52 offen lds
    s_mov_b32 s52, 688128
    s_add_u32 m0, s75, 69632
    s_nop 0
    buffer_load_dwordx4 v124, s[64:67], s52 offen lds
    s_mov_b32 s52, 786432
    s_add_u32 m0, s74, 49152
    s_nop 0
    buffer_load_dwordx4 v120, s[56:59], s52 offen lds
    s_mov_b32 s52, 786432
    s_add_u32 m0, s74, 50176
    s_nop 0
    buffer_load_dwordx4 v121, s[56:59], s52 offen lds
    s_mov_b32 s52, 786432
    s_add_u32 m0, s74, 51200
    s_nop 0
    buffer_load_dwordx4 v122, s[56:59], s52 offen lds
    s_mov_b32 s52, 786432
    s_add_u32 m0, s74, 52224
    s_nop 0
    buffer_load_dwordx4 v123, s[56:59], s52 offen lds
    s_waitcnt vmcnt(12)
    s_barrier
    s_mov_b32 s52, 802816
    s_add_u32 m0, s75, 90112
    s_nop 0
    buffer_load_dwordx4 v124, s[60:63], s52 offen lds
    s_mov_b32 s52, 802816
    s_add_u32 m0, s75, 94208
    s_nop 0
    buffer_load_dwordx4 v124, s[64:67], s52 offen lds
    s_mov_b32 s52, 917504
    s_add_u32 m0, s74, 73728
    s_nop 0
    buffer_load_dwordx4 v120, s[56:59], s52 offen lds
    s_mov_b32 s52, 917504
    s_add_u32 m0, s74, 74752
    s_nop 0
    buffer_load_dwordx4 v121, s[56:59], s52 offen lds
    s_mov_b32 s52, 917504
    s_add_u32 m0, s74, 75776
    s_nop 0
    buffer_load_dwordx4 v122, s[56:59], s52 offen lds
    s_mov_b32 s52, 917504
    s_add_u32 m0, s74, 76800
    s_nop 0
    buffer_load_dwordx4 v123, s[56:59], s52 offen lds
    s_waitcnt vmcnt(12)
    s_barrier
    s_mov_b32 s52, 917504
    s_add_u32 m0, s75, 16384
    s_nop 0
    buffer_load_dwordx4 v124, s[60:63], s52 offen lds
    s_mov_b32 s52, 917504
    s_add_u32 m0, s75, 20480
    s_nop 0
    buffer_load_dwordx4 v124, s[64:67], s52 offen lds
    s_mov_b32 s52, 1048576
    s_add_u32 m0, s74, 0
    s_nop 0
    buffer_load_dwordx4 v120, s[56:59], s52 offen lds
    s_mov_b32 s52, 1048576
    s_add_u32 m0, s74, 1024
    s_nop 0
    buffer_load_dwordx4 v121, s[56:59], s52 offen lds
    s_mov_b32 s52, 1048576
    s_add_u32 m0, s74, 2048
    s_nop 0
    buffer_load_dwordx4 v122, s[56:59], s52 offen lds
    s_mov_b32 s52, 1048576
    s_add_u32 m0, s74, 3072
    s_nop 0
    buffer_load_dwordx4 v123, s[56:59], s52 offen lds
    s_waitcnt vmcnt(12)
    s_barrier
    s_mov_b32 s52, 1032192
    s_add_u32 m0, s75, 40960
    s_nop 0
    buffer_load_dwordx4 v124, s[60:63], s52 offen lds
    s_mov_b32 s52, 1032192
    s_add_u32 m0, s75, 45056
    s_nop 0
    buffer_load_dwordx4 v124, s[64:67], s52 offen lds
    s_mov_b32 s52, 1179648
    s_add_u32 m0, s74, 24576
    s_nop 0
    buffer_load_dwordx4 v120, s[56:59], s52 offen lds
    s_mov_b32 s52, 1179648
    s_add_u32 m0, s74, 25600
    s_nop 0
    buffer_load_dwordx4 v121, s[56:59], s52 offen lds
    s_mov_b32 s52, 1179648
    s_add_u32 m0, s74, 26624
    s_nop 0
    buffer_load_dwordx4 v122, s[56:59], s52 offen lds
    s_mov_b32 s52, 1179648
    s_add_u32 m0, s74, 27648
    s_nop 0
    buffer_load_dwordx4 v123, s[56:59], s52 offen lds
    s_waitcnt vmcnt(12)
    s_barrier
    s_cmp_eq_u32 s54, 1
    s_cbranch_scc1 L_k2_x1
    v_cmp_lt_u32_e64 vcc, 31, v2
    v_mov_b32 v126, 6912
    s_nop 0
    v_cndmask_b32 v126, 0, v126, vcc
    v_lshl_add_u32 v126, v2, 3, v126
    s_lshl_b32 s52, s49, 8
    s_add_u32 s52, s52, 11534336
    v_add_u32_e64 v126, s52, v126
    s_mov_b32 s52, 0
    buffer_load_dwordx2 v[128:129], v126, s[56:59], s52 offen
    s_mov_b32 s52, 14336
    buffer_load_dwordx2 v[130:131], v126, s[56:59], s52 offen
    s_mov_b32 s52, 28672
    buffer_load_dwordx2 v[132:133], v126, s[56:59], s52 offen
    s_mov_b32 s52, 43008
    buffer_load_dwordx2 v[134:135], v126, s[56:59], s52 offen
    s_branch L_k2_x2
L_k2_x1:
    s_lshl_b32 s52, s50, 11
    s_add_u32 s52, s52, 24576
    v_lshl_add_u32 v126, v2, 3, s52
    buffer_load_dwordx2 v[128:129], v126, s[56:59], 0 offen offset:0 sc1
    buffer_load_dwordx2 v[130:131], v126, s[56:59], 0 offen offset:512 sc1
    buffer_load_dwordx2 v[132:133], v126, s[56:59], 0 offen offset:1024 sc1
    buffer_load_dwordx2 v[134:135], v126, s[56:59], 0 offen offset:1536 sc1
L_k2_x2:
    v_lshrrev_b32 v138, 3, v2
    v_lshlrev_b32 v138, 12, v138
    v_and_b32_e64 v139, 7, v2
    v_lshl_add_u32 v138, v139, 4, v138
    s_lshr_b32 s51, s78, 2
    s_lshl_b32 s51, s51, 2
    s_add_u32 s51, s51, s54
    s_lshl_b32 s51, s51, 16
    s_and_b32 s52, s78, 3
    s_lshl_b32 s52, s52, 7
    s_add_u32 s51, s51, s52
    s_lshl_b32 s52, s77, 9
    s_add_u32 s51, s51, s52
    s_add_u32 s51, s51, 65536
    s_lshl_b32 s52, s54, 11
    s_add_u32 m0, s52, 150016
    s_nop 0
    buffer_load_dwordx4 v138, s[56:59], s51 offen lds
    s_add_u32 s51, s51, 32768
    s_add_u32 m0, s52, 151040
    s_nop 0
    buffer_load_dwordx4 v138, s[56:59], s51 offen lds
    s_mov_b32 s52, 1146880
    s_add_u32 m0, s75, 65536
    s_nop 0
    buffer_load_dwordx4 v124, s[60:63], s52 offen lds
    s_mov_b32 s52, 1146880
    s_add_u32 m0, s75, 69632
    s_nop 0
    buffer_load_dwordx4 v124, s[64:67], s52 offen lds
    s_mov_b32 s52, 1310720
    s_add_u32 m0, s74, 49152
    s_nop 0
    buffer_load_dwordx4 v120, s[56:59], s52 offen lds
    s_mov_b32 s52, 1310720
    s_add_u32 m0, s74, 50176
    s_nop 0
    buffer_load_dwordx4 v121, s[56:59], s52 offen lds
    s_mov_b32 s52, 1310720
    s_add_u32 m0, s74, 51200
    s_nop 0
    buffer_load_dwordx4 v122, s[56:59], s52 offen lds
    s_mov_b32 s52, 1310720
    s_add_u32 m0, s74, 52224
    s_nop 0
    buffer_load_dwordx4 v123, s[56:59], s52 offen lds
    s_waitcnt vmcnt(18)
    s_barrier
    s_mov_b32 s52, 1261568
    s_add_u32 m0, s75, 90112
    s_nop 0
    buffer_load_dwordx4 v124, s[60:63], s52 offen lds
    s_mov_b32 s52, 1261568
    s_add_u32 m0, s75, 94208
    s_nop 0
    buffer_load_dwordx4 v124, s[64:67], s52 offen lds
    s_mov_b32 s52, 1441792
    s_add_u32 m0, s74, 73728
    s_nop 0
    buffer_load_dwordx4 v120, s[56:59], s52 offen lds
    s_mov_b32 s52, 1441792
    s_add_u32 m0, s74, 74752
    s_nop 0
    buffer_load_dwordx4 v121, s[56:59], s52 offen lds
    s_mov_b32 s52, 1441792
    s_add_u32 m0, s74, 75776
    s_nop 0
    buffer_load_dwordx4 v122, s[56:59], s52 offen lds
    s_mov_b32 s52, 1441792
    s_add_u32 m0, s74, 76800
    s_nop 0
    buffer_load_dwordx4 v123, s[56:59], s52 offen lds
    s_waitcnt vmcnt(18)
    s_barrier
    s_mov_b32 s52, 1376256
    s_add_u32 m0, s75, 16384
    s_nop 0
    buffer_load_dwordx4 v124, s[60:63], s52 offen lds
    s_mov_b32 s52, 1376256
    s_add_u32 m0, s75, 20480
    s_nop 0
    buffer_load_dwordx4 v124, s[64:67], s52 offen lds
    s_mov_b32 s52, 1572864
    s_add_u32 m0, s74, 0
    s_nop 0
    buffer_load_dwordx4 v120, s[56:59], s52 offen lds
    s_mov_b32 s52, 1572864
    s_add_u32 m0, s74, 1024
    s_nop 0
    buffer_load_dwordx4 v121, s[56:59], s52 offen lds
    s_mov_b32 s52, 1572864
    s_add_u32 m0, s74, 2048
    s_nop 0
    buffer_load_dwordx4 v122, s[56:59], s52 offen lds
    s_mov_b32 s52, 1572864
    s_add_u32 m0, s74, 3072
    s_nop 0
    buffer_load_dwordx4 v123, s[56:59], s52 offen lds
    s_waitcnt vmcnt(12)
    s_barrier
    s_mov_b32 s52, 1490944
    s_add_u32 m0, s75, 40960
    s_nop 0
    buffer_load_dwordx4 v124, s[60:63], s52 offen lds
    s_mov_b32 s52, 1490944
    s_add_u32 m0, s75, 45056
    s_nop 0
    buffer_load_dwordx4 v124, s[64:67], s52 offen lds
    s_mov_b32 s52, 1703936
    s_add_u32 m0, s74, 24576
    s_nop 0
    buffer_load_dwordx4 v120, s[56:59], s52 offen lds
    s_mov_b32 s52, 1703936
    s_add_u32 m0, s74, 25600
    s_nop 0
    buffer_load_dwordx4 v121, s[56:59], s52 offen lds
    s_mov_b32 s52, 1703936
    s_add_u32 m0, s74, 26624
    s_nop 0
    buffer_load_dwordx4 v122, s[56:59], s52 offen lds
    s_mov_b32 s52, 1703936
    s_add_u32 m0, s74, 27648
    s_nop 0
    buffer_load_dwordx4 v123, s[56:59], s52 offen lds
    s_waitcnt vmcnt(12)
    s_cmp_eq_u32 s54, 1
    s_cbranch_scc1 L_k2_y1
    s_cmp_lg_u32 s54, 0
    s_cbranch_scc1 L_k2_y2
    v_pk_add_f32 v[128:129], v[128:129], v[130:131]
    v_pk_add_f32 v[132:133], v[132:133], v[134:135]
    v_pk_add_f32 v[128:129], v[128:129], v[132:133]
    v_lshlrev_b32_e64 v126, 3, v2
    v_add_u32 v126, 147456, v126
    ds_write_b64 v126, v[128:129]
    s_branch L_k2_y2
L_k2_y1:
    s_waitcnt lgkmcnt(0)
    v_xor_b32 v136, s55, v129
    v_xor_b32 v137, s55, v131
    v_or_b32 v136, v136, v137
    v_xor_b32 v137, s55, v133
    v_or_b32 v136, v136, v137
    v_xor_b32 v137, s55, v135
    v_or_b32 v136, v136, v137
    v_cmp_ne_u32_e64 vcc, 0, v136
    s_cbranch_vccz L_k2_y1ok
    buffer_load_dwordx2 v[128:129], v126, s[56:59], 0 offen offset:0 sc1
    buffer_load_dwordx2 v[130:131], v126, s[56:59], 0 offen offset:512 sc1
    buffer_load_dwordx2 v[132:133], v126, s[56:59], 0 offen offset:1024 sc1
    buffer_load_dwordx2 v[134:135], v126, s[56:59], 0 offen offset:1536 sc1
    s_waitcnt vmcnt(0)
    s_branch L_k2_y1
L_k2_y1ok:
    v_lshlrev_b32_e64 v126, 3, v2
    v_add_u32 v126, 147968, v126
    v_lshlrev_b32_e64 v128, 16, v128
    v_xor_b32 v128, 0x80000000, v128
    ds_write_b64 v126, v[128:129] offset:0
    v_lshlrev_b32_e64 v130, 16, v130
    v_xor_b32 v130, 0x80000000, v130
    ds_write_b64 v126, v[130:131] offset:512
    v_lshlrev_b32_e64 v132, 16, v132
    v_xor_b32 v132, 0x80000000, v132
    ds_write_b64 v126, v[132:133] offset:1024
    v_lshlrev_b32_e64 v134, 16, v134
    v_xor_b32 v134, 0x80000000, v134
    ds_write_b64 v126, v[134:135] offset:1536
L_k2_y2:
    s_waitcnt lgkmcnt(0)
    s_barrier
    s_add_u32 s51, s72, 0
    s_add_u32 m0, s75, 98304
    s_nop 0
    buffer_load_dwordx4 v127, s[56:59], s51 offen lds
    s_add_u32 s51, s72, 57344
    s_add_u32 m0, s75, 102400
    s_nop 0
    buffer_load_dwordx4 v127, s[56:59], s51 offen lds
    s_add_u32 s51, s72, 114688
    s_add_u32 m0, s75, 106496
    s_nop 0
    buffer_load_dwordx4 v127, s[56:59], s51 offen lds
    s_add_u32 s51, s72, 172032
    s_add_u32 m0, s75, 110592
    s_nop 0
    buffer_load_dwordx4 v127, s[56:59], s51 offen lds
    s_add_u32 s51, s72, 1024
    s_add_u32 m0, s75, 114688
    s_nop 0
    buffer_load_dwordx4 v127, s[56:59], s51 offen lds
    s_add_u32 s51, s72, 58368
    s_add_u32 m0, s75, 118784
    s_nop 0
    buffer_load_dwordx4 v127, s[56:59], s51 offen lds
    s_add_u32 s51, s72, 115712
    s_add_u32 m0, s75, 122880
    s_nop 0
    buffer_load_dwordx4 v127, s[56:59], s51 offen lds
    s_add_u32 s51, s72, 173056
    s_add_u32 m0, s75, 126976
    s_nop 0
    buffer_load_dwordx4 v127, s[56:59], s51 offen lds
    s_waitcnt vmcnt(14)
    s_barrier
    s_add_u32 s51, s72, 2048
    s_add_u32 m0, s75, 131072
    s_nop 0
    buffer_load_dwordx4 v127, s[56:59], s51 offen lds
    s_add_u32 s51, s72, 59392
    s_add_u32 m0, s75, 135168
    s_nop 0
    buffer_load_dwordx4 v127, s[56:59], s51 offen lds
    s_add_u32 s51, s72, 116736
    s_add_u32 m0, s75, 139264
    s_nop 0
    buffer_load_dwordx4 v127, s[56:59], s51 offen lds
    s_add_u32 s51, s72, 174080
    s_add_u32 m0, s75, 143360
    s_nop 0
    buffer_load_dwordx4 v127, s[56:59], s51 offen lds
    s_add_u32 s51, s72, 3072
    s_add_u32 m0, s75, 49152
    s_nop 0
    buffer_load_dwordx4 v127, s[56:59], s51 offen lds
    s_add_u32 s51, s72, 60416
    s_add_u32 m0, s75, 53248
    s_nop 0
    buffer_load_dwordx4 v127, s[56:59], s51 offen lds
    s_add_u32 s51, s72, 117760
    s_add_u32 m0, s75, 57344
    s_nop 0
    buffer_load_dwordx4 v127, s[56:59], s51 offen lds
    s_add_u32 s51, s72, 175104
    s_add_u32 m0, s75, 61440
    s_nop 0
    buffer_load_dwordx4 v127, s[56:59], s51 offen lds
    s_waitcnt vmcnt(16)
    s_barrier
    s_add_u32 s51, s72, 4096
    s_add_u32 m0, s75, 65536
    s_nop 0
    buffer_load_dwordx4 v127, s[56:59], s51 offen lds
    s_add_u32 s51, s72, 61440
    s_add_u32 m0, s75, 69632
    s_nop 0
    buffer_load_dwordx4 v127, s[56:59], s51 offen lds
    s_add_u32 s51, s72, 118784
    s_add_u32 m0, s75, 73728
    s_nop 0
    buffer_load_dwordx4 v127, s[56:59], s51 offen lds
    s_add_u32 s51, s72, 176128
    s_add_u32 m0, s75, 77824
    s_nop 0
    buffer_load_dwordx4 v127, s[56:59], s51 offen lds
    s_add_u32 s51, s72, 5120
    s_add_u32 m0, s75, 81920
    s_nop 0
    buffer_load_dwordx4 v127, s[56:59], s51 offen lds
    s_add_u32 s51, s72, 62464
    s_add_u32 m0, s75, 86016
    s_nop 0
    buffer_load_dwordx4 v127, s[56:59], s51 offen lds
    s_add_u32 s51, s72, 119808
    s_add_u32 m0, s75, 90112
    s_nop 0
    buffer_load_dwordx4 v127, s[56:59], s51 offen lds
    s_add_u32 s51, s72, 177152
    s_add_u32 m0, s75, 94208
    s_nop 0
    buffer_load_dwordx4 v127, s[56:59], s51 offen lds
    s_add_u32 s51, s72, 6144
    s_add_u32 m0, s75, 0
    s_nop 0
    buffer_load_dwordx4 v127, s[56:59], s51 offen lds
    s_add_u32 s51, s72, 63488
    s_add_u32 m0, s75, 4096
    s_nop 0
    buffer_load_dwordx4 v127, s[56:59], s51 offen lds
    s_add_u32 s51, s72, 120832
    s_add_u32 m0, s75, 8192
    s_nop 0
    buffer_load_dwordx4 v127, s[56:59], s51 offen lds
    s_add_u32 s51, s72, 178176
    s_add_u32 m0, s75, 12288
    s_nop 0
    buffer_load_dwordx4 v127, s[56:59], s51 offen lds
    s_waitcnt vmcnt(0)
    s_barrier
    s_add_u32 s51, s72, 0
    s_nop 0
    buffer_load_dwordx4 v[8:11], v3, s[56:59], s51 offen
    s_add_u32 s51, s72, 57344
    buffer_load_dwordx4 v[12:15], v3, s[56:59], s51 offen
    s_add_u32 s51, s72, 114688
    buffer_load_dwordx4 v[16:19], v3, s[56:59], s51 offen
    s_add_u32 s51, s72, 172032
    buffer_load_dwordx4 v[20:23], v3, s[56:59], s51 offen
    s_add_u32 s51, s72, 1024
    buffer_load_dwordx4 v[24:27], v3, s[56:59], s51 offen
    s_add_u32 s51, s72, 58368
    buffer_load_dwordx4 v[28:31], v3, s[56:59], s51 offen
    s_add_u32 s51, s72, 115712
    buffer_load_dwordx4 v[32:35], v3, s[56:59], s51 offen
    s_add_u32 s51, s72, 173056
    buffer_load_dwordx4 v[36:39], v3, s[56:59], s51 offen
    s_add_u32 s51, s72, 2048
    buffer_load_dwordx4 v[40:43], v3, s[56:59], s51 offen
    s_add_u32 s51, s72, 59392
    buffer_load_dwordx4 v[44:47], v3, s[56:59], s51 offen
    s_add_u32 s51, s72, 116736
    buffer_load_dwordx4 v[48:51], v3, s[56:59], s51 offen
    s_add_u32 s51, s72, 174080
    buffer_load_dwordx4 v[52:55], v3, s[56:59], s51 offen
    s_add_u32 s51, s72, 3072
    buffer_load_dwordx4 v[56:59], v3, s[56:59], s51 offen
    s_add_u32 s51, s72, 60416
    buffer_load_dwordx4 v[60:63], v3, s[56:59], s51 offen
    s_add_u32 s51, s72, 117760
    buffer_load_dwordx4 v[64:67], v3, s[56:59], s51 offen
    s_add_u32 s51, s72, 175104
    buffer_load_dwordx4 v[68:71], v3, s[56:59], s51 offen
    s_add_u32 s51, s72, 4096
    buffer_load_dwordx4 v[72:75], v3, s[56:59], s51 offen
    s_add_u32 s51, s72, 61440
    buffer_load_dwordx4 v[76:79], v3, s[56:59], s51 offen
    s_add_u32 s51, s72, 118784
    buffer_load_dwordx4 v[80:83], v3, s[56:59], s51 offen
    s_add_u32 s51, s72, 176128
    buffer_load_dwordx4 v[84:87], v3, s[56:59], s51 offen
    s_add_u32 s51, s72, 5120
    buffer_load_dwordx4 v[88:91], v3, s[56:59], s51 offen
    s_add_u32 s51, s72, 62464
    buffer_load_dwordx4 v[92:95], v3, s[56:59], s51 offen
    s_add_u32 s51, s72, 119808
    buffer_load_dwordx4 v[96:99], v3, s[56:59], s51 offen
    s_add_u32 s51, s72, 177152
    buffer_load_dwordx4 v[100:103], v3, s[56:59], s51 offen
    s_add_u32 s51, s72, 6144
    buffer_load_dwordx4 v[104:107], v3, s[56:59], s51 offen
    s_add_u32 s51, s72, 63488
    buffer_load_dwordx4 v[108:111], v3, s[56:59], s51 offen
    s_add_u32 s51, s72, 120832
    buffer_load_dwordx4 v[112:115], v3, s[56:59], s51 offen
    s_add_u32 s51, s72, 178176
    buffer_load_dwordx4 v[116:119], v3, s[56:59], s51 offen
L_k2_sync:
    v_and_b32 v4, 15, v2
    v_lshrrev_b32 v5, 4, v2
    s_lshr_b32 s51, s48, 1
    s_lshl_b32 s51, s51, 4
    s_lshr_b32 s52, s78, 2
    s_lshl_b32 s52, s52, 6
    s_add_u32 s68, s51, s52
    s_and_b32 s51, s48, 1
    s_lshl_b32 s51, s51, 4
    s_and_b32 s52, s78, 3
    s_lshl_b32 s52, s52, 6
    s_add_u32 s69, s51, s52
    s_lshl_b32 s51, s77, 8
    s_add_u32 s69, s69, s51
    v_add_u32_e64 v6, s69, v4
    v_lshl_add_u32 v7, v5, 2, s68
    v_lshrrev_b32 v121, 2, v2
    v_lshlrev_b32 v121, 7, v121
    v_and_b32_e64 v123, 3, v2
    v_lshl_add_u32 v121, v123, 3, v121
    s_lshr_b32 s51, s48, 1
    s_lshl_b32 s51, s51, 11
    s_and_b32 s52, s48, 1
    s_lshl_b32 s52, s52, 5
    s_add_u32 s51, s51, s52
    s_add_u32 s51, s51, 150016
    v_add_u32 v121, s51, v121
    ds_read_b64_tr_b16 v[184:185], v121
    ds_read_b64_tr_b16 v[186:187], v121 offset:64
    v_mul_u32_u24 v122, 896, v6
    v_lshl_add_u32 v122, v7, 1, v122
    v_lshlrev_b32_e64 v0, 3, v6
    v_add_u32 v0, 24576, v0
    s_lshl_b32 s51, s48, 13
    v_lshl_add_u32 v125, v2, 4, s51
    v_add_u32 v127, 65536, v125
    s_lshl_b32 s51, s48, 10
    v_lshl_add_u32 v126, v2, 4, s51
    v_add_u32 v120, 65536, v126
    v_and_b32 v4, 3, v2
    v_lshlrev_b32 v4, 7, v4
L_k2_poll:
    buffer_load_dword v5, v4, s[56:59], s79 offen sc1
    s_waitcnt vmcnt(0)
    v_cmp_ne_u32_e64 vcc, s55, v5
    s_cbranch_vccnz L_k2_poll
    s_waitcnt lgkmcnt(0)
    s_add_u32 s51, s73, 0
    buffer_load_dwordx4 v[128:131], v3, s[56:59], s51 offen sc1
    s_add_u32 s51, s73, 1024
    buffer_load_dwordx4 v[132:135], v3, s[56:59], s51 offen sc1
    s_add_u32 s51, s73, 2048
    buffer_load_dwordx4 v[136:139], v3, s[56:59], s51 offen sc1
    s_add_u32 s51, s73, 3072
    buffer_load_dwordx4 v[140:143], v3, s[56:59], s51 offen sc1
    s_add_u32 s51, s73, 4096
    buffer_load_dwordx4 v[144:147], v3, s[56:59], s51 offen sc1
    s_add_u32 s51, s73, 5120
    buffer_load_dwordx4 v[148:151], v3, s[56:59], s51 offen sc1
    s_add_u32 s51, s73, 6144
    buffer_load_dwordx4 v[152:155], v3, s[56:59], s51 offen sc1
    s_add_u32 s51, s73, 57344
    buffer_load_dwordx4 v[156:159], v3, s[56:59], s51 offen sc1
    s_waitcnt vmcnt(7)
    s_nop 0
    v_mfma_f32_16x16x32_bf16 v[192:195], v[8:11], v[128:131], 0
    v_mfma_f32_16x16x32_bf16 v[200:203], v[12:15], v[128:131], 0
    v_mfma_f32_16x16x32_bf16 v[208:211], v[16:19], v[128:131], 0
    v_mfma_f32_16x16x32_bf16 v[216:219], v[20:23], v[128:131], 0
    s_add_u32 s51, s73, 58368
    buffer_load_dwordx4 v[128:131], v3, s[56:59], s51 offen sc1
    s_waitcnt vmcnt(7)
    s_nop 0
    v_mfma_f32_16x16x32_bf16 v[192:195], v[24:27], v[132:135], v[192:195]
    v_mfma_f32_16x16x32_bf16 v[200:203], v[28:31], v[132:135], v[200:203]
    v_mfma_f32_16x16x32_bf16 v[208:211], v[32:35], v[132:135], v[208:211]
    v_mfma_f32_16x16x32_bf16 v[216:219], v[36:39], v[132:135], v[216:219]
    s_add_u32 s51, s73, 59392
    buffer_load_dwordx4 v[132:135], v3, s[56:59], s51 offen sc1
    s_waitcnt vmcnt(7)
    s_nop 0
    v_mfma_f32_16x16x32_bf16 v[192:195], v[40:43], v[136:139], v[192:195]
    v_mfma_f32_16x16x32_bf16 v[200:203], v[44:47], v[136:139], v[200:203]
    v_mfma_f32_16x16x32_bf16 v[208:211], v[48:51], v[136:139], v[208:211]
    v_mfma_f32_16x16x32_bf16 v[216:219], v[52:55], v[136:139], v[216:219]
    s_add_u32 s51, s73, 60416
    buffer_load_dwordx4 v[136:139], v3, s[56:59], s51 offen sc1
    s_waitcnt vmcnt(7)
    s_nop 0
    v_mfma_f32_16x16x32_bf16 v[192:195], v[56:59], v[140:143], v[192:195]
    v_mfma_f32_16x16x32_bf16 v[200:203], v[60:63], v[140:143], v[200:203]
    v_mfma_f32_16x16x32_bf16 v[208:211], v[64:67], v[140:143], v[208:211]
    v_mfma_f32_16x16x32_bf16 v[216:219], v[68:71], v[140:143], v[216:219]
    s_add_u32 s51, s73, 61440
    buffer_load_dwordx4 v[140:143], v3, s[56:59], s51 offen sc1
    s_waitcnt vmcnt(7)
    s_nop 0
    v_mfma_f32_16x16x32_bf16 v[192:195], v[72:75], v[144:147], v[192:195]
    v_mfma_f32_16x16x32_bf16 v[200:203], v[76:79], v[144:147], v[200:203]
    v_mfma_f32_16x16x32_bf16 v[208:211], v[80:83], v[144:147], v[208:211]
    v_mfma_f32_16x16x32_bf16 v[216:219], v[84:87], v[144:147], v[216:219]
    s_add_u32 s51, s73, 62464
    buffer_load_dwordx4 v[144:147], v3, s[56:59], s51 offen sc1
    s_waitcnt vmcnt(7)
    s_nop 0
    v_mfma_f32_16x16x32_bf16 v[192:195], v[88:91], v[148:151], v[192:195]
    v_mfma_f32_16x16x32_bf16 v[200:203], v[92:95], v[148:151], v[200:203]
    v_mfma_f32_16x16x32_bf16 v[208:211], v[96:99], v[148:151], v[208:211]
    v_mfma_f32_16x16x32_bf16 v[216:219], v[100:103], v[148:151], v[216:219]
    s_add_u32 s51, s73, 63488
    buffer_load_dwordx4 v[148:151], v3, s[56:59], s51 offen sc1
    s_waitcnt vmcnt(7)
    s_nop 0
    v_mfma_f32_16x16x32_bf16 v[192:195], v[104:107], v[152:155], v[192:195]
    v_mfma_f32_16x16x32_bf16 v[200:203], v[108:111], v[152:155], v[200:203]
    v_mfma_f32_16x16x32_bf16 v[208:211], v[112:115], v[152:155], v[208:211]
    v_mfma_f32_16x16x32_bf16 v[216:219], v[116:119], v[152:155], v[216:219]
    s_add_u32 s51, s73, 114688
    buffer_load_dwordx4 v[152:155], v3, s[56:59], s51 offen sc1
    s_waitcnt vmcnt(7)
    s_nop 0
    v_mfma_f32_16x16x32_bf16 v[196:199], v[8:11], v[156:159], 0
    v_mfma_f32_16x16x32_bf16 v[204:207], v[12:15], v[156:159], 0
    v_mfma_f32_16x16x32_bf16 v[212:215], v[16:19], v[156:159], 0
    v_mfma_f32_16x16x32_bf16 v[220:223], v[20:23], v[156:159], 0
    s_add_u32 s51, s73, 115712
    buffer_load_dwordx4 v[156:159], v3, s[56:59], s51 offen sc1
    s_waitcnt vmcnt(7)
    s_nop 0
    v_mfma_f32_16x16x32_bf16 v[196:199], v[24:27], v[128:131], v[196:199]
    v_mfma_f32_16x16x32_bf16 v[204:207], v[28:31], v[128:131], v[204:207]
    v_mfma_f32_16x16x32_bf16 v[212:215], v[32:35], v[128:131], v[212:215]
    v_mfma_f32_16x16x32_bf16 v[220:223], v[36:39], v[128:131], v[220:223]
    s_add_u32 s51, s73, 116736
    buffer_load_dwordx4 v[128:131], v3, s[56:59], s51 offen sc1
    s_barrier
    ds_write_b128 v125, v[192:195] offset:0
    ds_write_b128 v125, v[200:203] offset:2048
    ds_write_b128 v125, v[208:211] offset:4096
    ds_write_b128 v125, v[216:219] offset:6144
    s_waitcnt vmcnt(7)
    v_mfma_f32_16x16x32_bf16 v[196:199], v[40:43], v[132:135], v[196:199]
    v_mfma_f32_16x16x32_bf16 v[204:207], v[44:47], v[132:135], v[204:207]
    v_mfma_f32_16x16x32_bf16 v[212:215], v[48:51], v[132:135], v[212:215]
    v_mfma_f32_16x16x32_bf16 v[220:223], v[52:55], v[132:135], v[220:223]
    s_add_u32 s51, s73, 117760
    buffer_load_dwordx4 v[132:135], v3, s[56:59], s51 offen sc1
    s_waitcnt vmcnt(7)
    s_nop 0
    v_mfma_f32_16x16x32_bf16 v[196:199], v[56:59], v[136:139], v[196:199]
    v_mfma_f32_16x16x32_bf16 v[204:207], v[60:63], v[136:139], v[204:207]
    v_mfma_f32_16x16x32_bf16 v[212:215], v[64:67], v[136:139], v[212:215]
    v_mfma_f32_16x16x32_bf16 v[220:223], v[68:71], v[136:139], v[220:223]
    s_add_u32 s51, s73, 118784
    buffer_load_dwordx4 v[136:139], v3, s[56:59], s51 offen sc1
    s_waitcnt vmcnt(7)
    s_nop 0
    v_mfma_f32_16x16x32_bf16 v[196:199], v[72:75], v[140:143], v[196:199]
    v_mfma_f32_16x16x32_bf16 v[204:207], v[76:79], v[140:143], v[204:207]
    v_mfma_f32_16x16x32_bf16 v[212:215], v[80:83], v[140:143], v[212:215]
    v_mfma_f32_16x16x32_bf16 v[220:223], v[84:87], v[140:143], v[220:223]
    s_add_u32 s51, s73, 119808
    buffer_load_dwordx4 v[140:143], v3, s[56:59], s51 offen sc1
    s_waitcnt vmcnt(7)
    s_nop 0
    v_mfma_f32_16x16x32_bf16 v[196:199], v[88:91], v[144:147], v[196:199]
    v_mfma_f32_16x16x32_bf16 v[204:207], v[92:95], v[144:147], v[204:207]
    v_mfma_f32_16x16x32_bf16 v[212:215], v[96:99], v[144:147], v[212:215]
    v_mfma_f32_16x16x32_bf16 v[220:223], v[100:103], v[144:147], v[220:223]
    s_add_u32 s51, s73, 120832
    buffer_load_dwordx4 v[144:147], v3, s[56:59], s51 offen sc1
    s_waitcnt vmcnt(7)
    s_nop 0
    v_mfma_f32_16x16x32_bf16 v[196:199], v[104:107], v[148:151], v[196:199]
    v_mfma_f32_16x16x32_bf16 v[204:207], v[108:111], v[148:151], v[204:207]
    v_mfma_f32_16x16x32_bf16 v[212:215], v[112:115], v[148:151], v[212:215]
    v_mfma_f32_16x16x32_bf16 v[220:223], v[116:119], v[148:151], v[220:223]
    s_add_u32 s51, s73, 172032
    buffer_load_dwordx4 v[148:151], v3, s[56:59], s51 offen sc1
    s_waitcnt vmcnt(7)
    s_nop 0
    v_mfma_f32_16x16x32_bf16 v[224:227], v[8:11], v[152:155], 0
    v_mfma_f32_16x16x32_bf16 v[232:235], v[12:15], v[152:155], 0
    v_mfma_f32_16x16x32_bf16 v[240:243], v[16:19], v[152:155], 0
    v_mfma_f32_16x16x32_bf16 v[248:251], v[20:23], v[152:155], 0
    s_add_u32 s51, s73, 173056
    buffer_load_dwordx4 v[152:155], v3, s[56:59], s51 offen sc1
    s_waitcnt vmcnt(7)
    s_nop 0
    v_mfma_f32_16x16x32_bf16 v[224:227], v[24:27], v[156:159], v[224:227]
    v_mfma_f32_16x16x32_bf16 v[232:235], v[28:31], v[156:159], v[232:235]
    v_mfma_f32_16x16x32_bf16 v[240:243], v[32:35], v[156:159], v[240:243]
    v_mfma_f32_16x16x32_bf16 v[248:251], v[36:39], v[156:159], v[248:251]
    s_add_u32 s51, s73, 174080
    buffer_load_dwordx4 v[156:159], v3, s[56:59], s51 offen sc1
    ds_write_b128 v125, v[196:199] offset:1024
    ds_write_b128 v125, v[204:207] offset:3072
    ds_write_b128 v125, v[212:215] offset:5120
    ds_write_b128 v125, v[220:223] offset:7168
    s_waitcnt vmcnt(7)
    s_nop 0
    v_mfma_f32_16x16x32_bf16 v[224:227], v[40:43], v[128:131], v[224:227]
    v_mfma_f32_16x16x32_bf16 v[232:235], v[44:47], v[128:131], v[232:235]
    v_mfma_f32_16x16x32_bf16 v[240:243], v[48:51], v[128:131], v[240:243]
    v_mfma_f32_16x16x32_bf16 v[248:251], v[52:55], v[128:131], v[248:251]
    s_add_u32 s51, s73, 175104
    buffer_load_dwordx4 v[128:131], v3, s[56:59], s51 offen sc1
    s_waitcnt vmcnt(7)
    s_nop 0
    v_mfma_f32_16x16x32_bf16 v[224:227], v[56:59], v[132:135], v[224:227]
    v_mfma_f32_16x16x32_bf16 v[232:235], v[60:63], v[132:135], v[232:235]
    v_mfma_f32_16x16x32_bf16 v[240:243], v[64:67], v[132:135], v[240:243]
    v_mfma_f32_16x16x32_bf16 v[248:251], v[68:71], v[132:135], v[248:251]
    s_add_u32 s51, s73, 176128
    buffer_load_dwordx4 v[132:135], v3, s[56:59], s51 offen sc1
    s_waitcnt vmcnt(7)
    s_nop 0
    v_mfma_f32_16x16x32_bf16 v[224:227], v[72:75], v[136:139], v[224:227]
    v_mfma_f32_16x16x32_bf16 v[232:235], v[76:79], v[136:139], v[232:235]
    v_mfma_f32_16x16x32_bf16 v[240:243], v[80:83], v[136:139], v[240:243]
    v_mfma_f32_16x16x32_bf16 v[248:251], v[84:87], v[136:139], v[248:251]
    s_add_u32 s51, s73, 177152
    buffer_load_dwordx4 v[136:139], v3, s[56:59], s51 offen sc1
    s_waitcnt vmcnt(7)
    s_nop 0
    v_mfma_f32_16x16x32_bf16 v[224:227], v[88:91], v[140:143], v[224:227]
    v_mfma_f32_16x16x32_bf16 v[232:235], v[92:95], v[140:143], v[232:235]
    v_mfma_f32_16x16x32_bf16 v[240:243], v[96:99], v[140:143], v[240:243]
    v_mfma_f32_16x16x32_bf16 v[248:251], v[100:103], v[140:143], v[248:251]
    s_add_u32 s51, s73, 178176
    buffer_load_dwordx4 v[140:143], v3, s[56:59], s51 offen sc1
    s_waitcnt vmcnt(7)
    s_nop 0
    v_mfma_f32_16x16x32_bf16 v[224:227], v[104:107], v[144:147], v[224:227]
    v_mfma_f32_16x16x32_bf16 v[232:235], v[108:111], v[144:147], v[232:235]
    v_mfma_f32_16x16x32_bf16 v[240:243], v[112:115], v[144:147], v[240:243]
    v_mfma_f32_16x16x32_bf16 v[248:251], v[116:119], v[144:147], v[248:251]
    buffer_load_dwordx2 v[188:189], v0, s[56:59], 0 offen sc1
    buffer_load_dwordx2 v[190:191], v0, s[56:59], 0 offen offset:256 sc1
    s_waitcnt vmcnt(8)
    v_mfma_f32_16x16x32_bf16 v[228:231], v[8:11], v[148:151], 0
    v_mfma_f32_16x16x32_bf16 v[236:239], v[12:15], v[148:151], 0
    v_mfma_f32_16x16x32_bf16 v[244:247], v[16:19], v[148:151], 0
    v_mfma_f32_16x16x32_bf16 v[252:255], v[20:23], v[148:151], 0
    s_waitcnt vmcnt(7)
    v_mfma_f32_16x16x32_bf16 v[228:231], v[24:27], v[152:155], v[228:231]
    v_mfma_f32_16x16x32_bf16 v[236:239], v[28:31], v[152:155], v[236:239]
    v_mfma_f32_16x16x32_bf16 v[244:247], v[32:35], v[152:155], v[244:247]
    v_mfma_f32_16x16x32_bf16 v[252:255], v[36:39], v[152:155], v[252:255]
    ds_write_b128 v127, v[224:227] offset:0
    ds_write_b128 v127, v[232:235] offset:2048
    ds_write_b128 v127, v[240:243] offset:4096
    ds_write_b128 v127, v[248:251] offset:6144
    s_waitcnt vmcnt(6)
    v_mfma_f32_16x16x32_bf16 v[228:231], v[40:43], v[156:159], v[228:231]
    v_mfma_f32_16x16x32_bf16 v[236:239], v[44:47], v[156:159], v[236:239]
    v_mfma_f32_16x16x32_bf16 v[244:247], v[48:51], v[156:159], v[244:247]
    v_mfma_f32_16x16x32_bf16 v[252:255], v[52:55], v[156:159], v[252:255]
    s_waitcnt vmcnt(5)
    v_mfma_f32_16x16x32_bf16 v[228:231], v[56:59], v[128:131], v[228:231]
    v_mfma_f32_16x16x32_bf16 v[236:239], v[60:63], v[128:131], v[236:239]
    v_mfma_f32_16x16x32_bf16 v[244:247], v[64:67], v[128:131], v[244:247]
    v_mfma_f32_16x16x32_bf16 v[252:255], v[68:71], v[128:131], v[252:255]
    s_waitcnt vmcnt(4)
    v_mfma_f32_16x16x32_bf16 v[228:231], v[72:75], v[132:135], v[228:231]
    v_mfma_f32_16x16x32_bf16 v[236:239], v[76:79], v[132:135], v[236:239]
    v_mfma_f32_16x16x32_bf16 v[244:247], v[80:83], v[132:135], v[244:247]
    v_mfma_f32_16x16x32_bf16 v[252:255], v[84:87], v[132:135], v[252:255]
    s_waitcnt vmcnt(3)
    v_mfma_f32_16x16x32_bf16 v[228:231], v[88:91], v[136:139], v[228:231]
    v_mfma_f32_16x16x32_bf16 v[236:239], v[92:95], v[136:139], v[236:239]
    v_mfma_f32_16x16x32_bf16 v[244:247], v[96:99], v[136:139], v[244:247]
    v_mfma_f32_16x16x32_bf16 v[252:255], v[100:103], v[136:139], v[252:255]
    s_waitcnt vmcnt(2)
    v_mfma_f32_16x16x32_bf16 v[228:231], v[104:107], v[140:143], v[228:231]
    v_mfma_f32_16x16x32_bf16 v[236:239], v[108:111], v[140:143], v[236:239]
    v_mfma_f32_16x16x32_bf16 v[244:247], v[112:115], v[140:143], v[244:247]
    v_mfma_f32_16x16x32_bf16 v[252:255], v[116:119], v[140:143], v[252:255]
    s_nop 4
    ds_write_b128 v127, v[228:231] offset:1024
    ds_write_b128 v127, v[236:239] offset:3072
    ds_write_b128 v127, v[244:247] offset:5120
    ds_write_b128 v127, v[252:255] offset:7168
L_k2_rs:
    s_waitcnt vmcnt(0)
    v_cmp_ne_u32 vcc, s55, v189
    v_cmp_ne_u32 s[68:69], s55, v191
    s_or_b64 vcc, vcc, s[68:69]
    s_cbranch_vccz L_k2_rsok
    buffer_load_dwordx2 v[188:189], v0, s[56:59], 0 offen sc1
    buffer_load_dwordx2 v[190:191], v0, s[56:59], 0 offen offset:256 sc1
    s_branch L_k2_rs
L_k2_rsok:
    v_and_b32 v123, 0xffff0000, v188
    v_mul_f32 v123, v123, v123
    v_rcp_f32_e64 v123, v123
    v_and_b32 v124, 0xffff0000, v190
    v_mul_f32 v124, v124, v124
    v_rcp_f32 v124, v124
    v_lshlrev_b32_e64 v176, 16, v184
    v_and_b32 v177, 0xffff0000, v184
    v_lshlrev_b32_e64 v178, 16, v185
    v_and_b32 v179, 0xffff0000, v185
    v_lshlrev_b32_e64 v180, 16, v186
    v_and_b32 v181, 0xffff0000, v186
    v_lshlrev_b32_e64 v182, 16, v187
    v_and_b32 v183, 0xffff0000, v187
    s_waitcnt lgkmcnt(0)
    s_barrier
    ds_read_b128 v[8:11], v126 offset:0
    ds_read_b128 v[12:15], v126 offset:8192
    ds_read_b128 v[16:19], v126 offset:16384
    ds_read_b128 v[20:23], v126 offset:24576
    ds_read_b128 v[24:27], v126 offset:32768
    ds_read_b128 v[28:31], v126 offset:40960
    ds_read_b128 v[32:35], v126 offset:49152
    ds_read_b128 v[36:39], v126 offset:57344
    ds_read_b128 v[40:43], v120 offset:0
    ds_read_b128 v[44:47], v120 offset:8192
    ds_read_b128 v[48:51], v120 offset:16384
    ds_read_b128 v[52:55], v120 offset:24576
    ds_read_b128 v[56:59], v120 offset:32768
    ds_read_b128 v[60:63], v120 offset:40960
    ds_read_b128 v[64:67], v120 offset:49152
    ds_read_b128 v[68:71], v120 offset:57344
    s_waitcnt lgkmcnt(11)
    v_pk_add_f32 v[8:9], v[8:9], v[24:25]
    v_pk_add_f32 v[10:11], v[10:11], v[26:27]
    s_waitcnt lgkmcnt(10)
    v_pk_add_f32 v[12:13], v[12:13], v[28:29]
    v_pk_add_f32 v[14:15], v[14:15], v[30:31]
    s_waitcnt lgkmcnt(9)
    v_pk_add_f32 v[16:17], v[16:17], v[32:33]
    v_pk_add_f32 v[18:19], v[18:19], v[34:35]
    s_waitcnt lgkmcnt(8)
    v_pk_add_f32 v[20:21], v[20:21], v[36:37]
    v_pk_add_f32 v[22:23], v[22:23], v[38:39]
    v_pk_add_f32 v[8:9], v[8:9], v[16:17]
    v_pk_add_f32 v[10:11], v[10:11], v[18:19]
    v_pk_add_f32 v[12:13], v[12:13], v[20:21]
    v_pk_add_f32 v[14:15], v[14:15], v[22:23]
    v_pk_add_f32 v[8:9], v[8:9], v[12:13]
    v_pk_add_f32 v[10:11], v[10:11], v[14:15]
    v_mul_f32 v8, v123, v8
    v_mul_f32 v9, v123, v9
    v_mul_f32 v10, v123, v10
    v_mul_f32 v11, v123, v11
    v_cvt_pk_bf16_f32 v12, v8, v9
    v_cvt_pk_bf16_f32 v13, v10, v11
    v_lshlrev_b32_e64 v8, 16, v12
    v_and_b32 v9, 0xffff0000, v12
    v_lshlrev_b32_e64 v10, 16, v13
    v_and_b32 v11, 0xffff0000, v13
    v_add_f32 v8, v8, v176
    v_add_f32 v9, v9, v177
    v_add_f32 v10, v10, v178
    v_add_f32 v11, v11, v179
    v_cvt_pk_bf16_f32 v12, v8, v9
    v_cvt_pk_bf16_f32 v13, v10, v11
    global_store_dwordx2 v122, v[12:13], s[42:43]
    s_waitcnt lgkmcnt(3)
    v_pk_add_f32 v[40:41], v[40:41], v[56:57]
    v_pk_add_f32 v[42:43], v[42:43], v[58:59]
    s_waitcnt lgkmcnt(2)
    v_pk_add_f32 v[44:45], v[44:45], v[60:61]
    v_pk_add_f32 v[46:47], v[46:47], v[62:63]
    s_waitcnt lgkmcnt(1)
    v_pk_add_f32 v[48:49], v[48:49], v[64:65]
    v_pk_add_f32 v[50:51], v[50:51], v[66:67]
    s_waitcnt lgkmcnt(0)
    v_pk_add_f32 v[52:53], v[52:53], v[68:69]
    v_pk_add_f32 v[54:55], v[54:55], v[70:71]
    v_pk_add_f32 v[40:41], v[40:41], v[48:49]
    v_pk_add_f32 v[42:43], v[42:43], v[50:51]
    v_pk_add_f32 v[44:45], v[44:45], v[52:53]
    v_pk_add_f32 v[46:47], v[46:47], v[54:55]
    v_pk_add_f32 v[40:41], v[40:41], v[44:45]
    v_pk_add_f32 v[42:43], v[42:43], v[46:47]
    v_mul_f32 v40, v124, v40
    v_mul_f32 v41, v124, v41
    v_mul_f32 v42, v124, v42
    v_mul_f32 v43, v124, v43
    v_cvt_pk_bf16_f32 v44, v40, v41
    v_cvt_pk_bf16_f32 v45, v42, v43
    v_lshlrev_b32_e64 v40, 16, v44
    v_and_b32 v41, 0xffff0000, v44
    v_lshlrev_b32_e64 v42, 16, v45
    v_and_b32 v43, 0xffff0000, v45
    v_add_f32 v40, v40, v180
    v_add_f32 v41, v41, v181
    v_add_f32 v42, v42, v182
    v_add_f32 v43, v43, v183
    v_cvt_pk_bf16_f32 v44, v40, v41
    v_cvt_pk_bf16_f32 v45, v42, v43
    v_add_u32 v122, 28672, v122
    global_store_dwordx2 v122, v[44:45], s[42:43]
    s_endpgm
L_k2_aux:
    s_waitcnt lgkmcnt(0)
    s_load_dword s55, s[46:47], 0
    s_mov_b32 s56, s46
    s_mov_b32 s57, s47
    s_mov_b32 s60, s36
    s_mov_b32 s61, s37
    s_mov_b32 s64, s38
    s_mov_b32 s65, s39
    s_sub_u32 s51, s78, 28
    s_lshl_b32 s51, s51, 6
    s_lshl_b32 s52, s77, 8
    s_add_u32 s53, s51, s52
    s_lshl_b32 s51, s53, 1
    s_add_u32 s51, s51, 65536
    v_and_b32 v3, 7, v0
    v_lshrrev_b32_e64 v4, 3, v0
    v_mul_u32_u24 v5, 28672, v4
    v_lshl_add_u32 v5, v3, 4, v5
    v_add_u32 v5, s51, v5
    s_mov_b32 s52, 0
    buffer_load_dwordx4 v[8:11], v5, s[56:59], s52 offen
    s_mov_b32 s52, 4096
    buffer_load_dwordx4 v[12:15], v5, s[56:59], s52 offen
    s_mov_b32 s52, 8192
    buffer_load_dwordx4 v[16:19], v5, s[56:59], s52 offen
    s_mov_b32 s52, 12288
    buffer_load_dwordx4 v[20:23], v5, s[56:59], s52 offen
    s_mov_b32 s52, 16384
    buffer_load_dwordx4 v[24:27], v5, s[56:59], s52 offen
    s_mov_b32 s52, 20480
    buffer_load_dwordx4 v[28:31], v5, s[56:59], s52 offen
    s_mov_b32 s52, 24576
    buffer_load_dwordx4 v[32:35], v5, s[56:59], s52 offen
    v_mov_b32 v48, 0
    v_mov_b32 v49, 0
    v_mov_b32 v50, 0
    v_mov_b32 v51, 0
    v_mov_b32 v52, 0
    v_mov_b32 v53, 0
    v_mov_b32 v54, 0
    v_mov_b32 v55, 0
    v_mov_b32 v56, 0
    v_mov_b32 v57, 0
    v_mov_b32 v58, 0
    v_mov_b32 v59, 0
    v_mov_b32 v60, 0
    v_mov_b32 v61, 0
    v_mov_b32 v62, 0
    v_mov_b32 v63, 0
    s_waitcnt vmcnt(6)
    v_lshlrev_b32 v40, 16, v8
    v_and_b32 v41, 0xffff0000, v8
    v_lshlrev_b32_e64 v42, 16, v9
    v_and_b32 v43, 0xffff0000, v9
    v_lshlrev_b32_e64 v44, 16, v10
    v_and_b32 v45, 0xffff0000, v10
    v_lshlrev_b32_e64 v46, 16, v11
    v_and_b32 v47, 0xffff0000, v11
    v_pk_add_f32 v[48:49], v[48:49], v[40:41]
    v_pk_fma_f32 v[56:57], v[40:41], v[40:41], v[56:57]
    v_pk_add_f32 v[50:51], v[50:51], v[42:43]
    v_pk_fma_f32 v[58:59], v[42:43], v[42:43], v[58:59]
    v_pk_add_f32 v[52:53], v[52:53], v[44:45]
    v_pk_fma_f32 v[60:61], v[44:45], v[44:45], v[60:61]
    v_pk_add_f32 v[54:55], v[54:55], v[46:47]
    v_pk_fma_f32 v[62:63], v[46:47], v[46:47], v[62:63]
    s_waitcnt vmcnt(5)
    v_lshlrev_b32 v40, 16, v12
    v_and_b32 v41, 0xffff0000, v12
    v_lshlrev_b32_e64 v42, 16, v13
    v_and_b32 v43, 0xffff0000, v13
    v_lshlrev_b32_e64 v44, 16, v14
    v_and_b32 v45, 0xffff0000, v14
    v_lshlrev_b32_e64 v46, 16, v15
    v_and_b32 v47, 0xffff0000, v15
    v_pk_add_f32 v[48:49], v[48:49], v[40:41]
    v_pk_fma_f32 v[56:57], v[40:41], v[40:41], v[56:57]
    v_pk_add_f32 v[50:51], v[50:51], v[42:43]
    v_pk_fma_f32 v[58:59], v[42:43], v[42:43], v[58:59]
    v_pk_add_f32 v[52:53], v[52:53], v[44:45]
    v_pk_fma_f32 v[60:61], v[44:45], v[44:45], v[60:61]
    v_pk_add_f32 v[54:55], v[54:55], v[46:47]
    v_pk_fma_f32 v[62:63], v[46:47], v[46:47], v[62:63]
    s_waitcnt vmcnt(4)
    v_lshlrev_b32 v40, 16, v16
    v_and_b32 v41, 0xffff0000, v16
    v_lshlrev_b32_e64 v42, 16, v17
    v_and_b32 v43, 0xffff0000, v17
    v_lshlrev_b32_e64 v44, 16, v18
    v_and_b32 v45, 0xffff0000, v18
    v_lshlrev_b32_e64 v46, 16, v19
    v_and_b32 v47, 0xffff0000, v19
    v_pk_add_f32 v[48:49], v[48:49], v[40:41]
    v_pk_fma_f32 v[56:57], v[40:41], v[40:41], v[56:57]
    v_pk_add_f32 v[50:51], v[50:51], v[42:43]
    v_pk_fma_f32 v[58:59], v[42:43], v[42:43], v[58:59]
    v_pk_add_f32 v[52:53], v[52:53], v[44:45]
    v_pk_fma_f32 v[60:61], v[44:45], v[44:45], v[60:61]
    v_pk_add_f32 v[54:55], v[54:55], v[46:47]
    v_pk_fma_f32 v[62:63], v[46:47], v[46:47], v[62:63]
    s_waitcnt vmcnt(3)
    v_lshlrev_b32 v40, 16, v20
    v_and_b32 v41, 0xffff0000, v20
    v_lshlrev_b32_e64 v42, 16, v21
    v_and_b32 v43, 0xffff0000, v21
    v_lshlrev_b32_e64 v44, 16, v22
    v_and_b32 v45, 0xffff0000, v22
    v_lshlrev_b32_e64 v46, 16, v23
    v_and_b32 v47, 0xffff0000, v23
    v_pk_add_f32 v[48:49], v[48:49], v[40:41]
    v_pk_fma_f32 v[56:57], v[40:41], v[40:41], v[56:57]
    v_pk_add_f32 v[50:51], v[50:51], v[42:43]
    v_pk_fma_f32 v[58:59], v[42:43], v[42:43], v[58:59]
    v_pk_add_f32 v[52:53], v[52:53], v[44:45]
    v_pk_fma_f32 v[60:61], v[44:45], v[44:45], v[60:61]
    v_pk_add_f32 v[54:55], v[54:55], v[46:47]
    v_pk_fma_f32 v[62:63], v[46:47], v[46:47], v[62:63]
    s_waitcnt vmcnt(2)
    v_lshlrev_b32 v40, 16, v24
    v_and_b32 v41, 0xffff0000, v24
    v_lshlrev_b32_e64 v42, 16, v25
    v_and_b32 v43, 0xffff0000, v25
    v_lshlrev_b32_e64 v44, 16, v26
    v_and_b32 v45, 0xffff0000, v26
    v_lshlrev_b32_e64 v46, 16, v27
    v_and_b32 v47, 0xffff0000, v27
    v_pk_add_f32 v[48:49], v[48:49], v[40:41]
    v_pk_fma_f32 v[56:57], v[40:41], v[40:41], v[56:57]
    v_pk_add_f32 v[50:51], v[50:51], v[42:43]
    v_pk_fma_f32 v[58:59], v[42:43], v[42:43], v[58:59]
    v_pk_add_f32 v[52:53], v[52:53], v[44:45]
    v_pk_fma_f32 v[60:61], v[44:45], v[44:45], v[60:61]
    v_pk_add_f32 v[54:55], v[54:55], v[46:47]
    v_pk_fma_f32 v[62:63], v[46:47], v[46:47], v[62:63]
    s_waitcnt vmcnt(1)
    v_lshlrev_b32 v40, 16, v28
    v_and_b32 v41, 0xffff0000, v28
    v_lshlrev_b32_e64 v42, 16, v29
    v_and_b32 v43, 0xffff0000, v29
    v_lshlrev_b32_e64 v44, 16, v30
    v_and_b32 v45, 0xffff0000, v30
    v_lshlrev_b32_e64 v46, 16, v31
    v_and_b32 v47, 0xffff0000, v31
    v_pk_add_f32 v[48:49], v[48:49], v[40:41]
    v_pk_fma_f32 v[56:57], v[40:41], v[40:41], v[56:57]
    v_pk_add_f32 v[50:51], v[50:51], v[42:43]
    v_pk_fma_f32 v[58:59], v[42:43], v[42:43], v[58:59]
    v_pk_add_f32 v[52:53], v[52:53], v[44:45]
    v_pk_fma_f32 v[60:61], v[44:45], v[44:45], v[60:61]
    v_pk_add_f32 v[54:55], v[54:55], v[46:47]
    v_pk_fma_f32 v[62:63], v[46:47], v[46:47], v[62:63]
    s_waitcnt vmcnt(0)
    v_lshlrev_b32 v40, 16, v32
    v_and_b32 v41, 0xffff0000, v32
    v_lshlrev_b32_e64 v42, 16, v33
    v_and_b32 v43, 0xffff0000, v33
    v_lshlrev_b32_e64 v44, 16, v34
    v_and_b32 v45, 0xffff0000, v34
    v_lshlrev_b32_e64 v46, 16, v35
    v_and_b32 v47, 0xffff0000, v35
    v_pk_add_f32 v[48:49], v[48:49], v[40:41]
    v_pk_fma_f32 v[56:57], v[40:41], v[40:41], v[56:57]
    v_pk_add_f32 v[50:51], v[50:51], v[42:43]
    v_pk_fma_f32 v[58:59], v[42:43], v[42:43], v[58:59]
    v_pk_add_f32 v[52:53], v[52:53], v[44:45]
    v_pk_fma_f32 v[60:61], v[44:45], v[44:45], v[60:61]
    v_pk_add_f32 v[54:55], v[54:55], v[46:47]
    v_pk_fma_f32 v[62:63], v[46:47], v[46:47], v[62:63]
    v_add_f32_dpp v48, v48, v48 row_ror:8 row_mask:0xf bank_mask:0xf
    v_add_f32_dpp v49, v49, v49 row_ror:8 row_mask:0xf bank_mask:0xf
    v_add_f32_dpp v50, v50, v50 row_ror:8 row_mask:0xf bank_mask:0xf
    v_add_f32_dpp v51, v51, v51 row_ror:8 row_mask:0xf bank_mask:0xf
    v_add_f32_dpp v52, v52, v52 row_ror:8 row_mask:0xf bank_mask:0xf
    v_add_f32_dpp v53, v53, v53 row_ror:8 row_mask:0xf bank_mask:0xf
    v_add_f32_dpp v54, v54, v54 row_ror:8 row_mask:0xf bank_mask:0xf
    v_add_f32_dpp v55, v55, v55 row_ror:8 row_mask:0xf bank_mask:0xf
    v_add_f32_dpp v56, v56, v56 row_ror:8 row_mask:0xf bank_mask:0xf
    v_add_f32_dpp v57, v57, v57 row_ror:8 row_mask:0xf bank_mask:0xf
    v_add_f32_dpp v58, v58, v58 row_ror:8 row_mask:0xf bank_mask:0xf
    v_add_f32_dpp v59, v59, v59 row_ror:8 row_mask:0xf bank_mask:0xf
    v_add_f32_dpp v60, v60, v60 row_ror:8 row_mask:0xf bank_mask:0xf
    v_add_f32_dpp v61, v61, v61 row_ror:8 row_mask:0xf bank_mask:0xf
    v_add_f32_dpp v62, v62, v62 row_ror:8 row_mask:0xf bank_mask:0xf
    v_add_f32_dpp v63, v63, v63 row_ror:8 row_mask:0xf bank_mask:0xf
    v_lshrrev_b32 v6, 4, v0
    v_lshlrev_b32 v6, 9, v6
    v_lshl_add_u32 v6, v3, 6, v6
    ds_write_b128 v6, v[48:51] offset:0
    ds_write_b128 v6, v[52:55] offset:16
    ds_write_b128 v6, v[56:59] offset:32
    ds_write_b128 v6, v[60:63] offset:48
    s_waitcnt lgkmcnt(0)
    s_barrier
    s_cmp_lg_u32 s48, 0
    s_cbranch_scc1 L_k2_apf
    v_lshrrev_b32 v6, 3, v2
    v_lshlrev_b32 v6, 6, v6
    v_and_b32_e64 v7, 7, v2
    v_lshl_add_u32 v6, v7, 2, v6
    ds_read2_b32 v[8:9], v6 offset0:0 offset1:8
    ds_read2_b32 v[10:11], v6 offset0:128 offset1:136
    v_add_u32 v6, 1024, v6
    ds_read2_b32 v[12:13], v6 offset0:0 offset1:8
    ds_read2_b32 v[14:15], v6 offset0:128 offset1:136
    v_add_u32 v6, 1024, v6
    ds_read2_b32 v[16:17], v6 offset0:0 offset1:8
    ds_read2_b32 v[18:19], v6 offset0:128 offset1:136
    v_add_u32 v6, 1024, v6
    ds_read2_b32 v[20:21], v6 offset0:0 offset1:8
    ds_read2_b32 v[22:23], v6 offset0:128 offset1:136
    v_add_u32 v6, 1024, v6
    ds_read2_b32 v[24:25], v6 offset0:0 offset1:8
    ds_read2_b32 v[26:27], v6 offset0:128 offset1:136
    v_add_u32 v6, 1024, v6
    ds_read2_b32 v[28:29], v6 offset0:0 offset1:8
    ds_read2_b32 v[30:31], v6 offset0:128 offset1:136
    v_add_u32 v6, 1024, v6
    ds_read2_b32 v[32:33], v6 offset0:0 offset1:8
    ds_read2_b32 v[34:35], v6 offset0:128 offset1:136
    v_add_u32 v6, 1024, v6
    ds_read2_b32 v[36:37], v6 offset0:0 offset1:8
    ds_read2_b32 v[38:39], v6 offset0:128 offset1:136
    v_add_u32 v6, 1024, v6
    ds_read2_b32 v[40:41], v6 offset0:0 offset1:8
    ds_read2_b32 v[42:43], v6 offset0:128 offset1:136
    v_add_u32 v6, 1024, v6
    ds_read2_b32 v[44:45], v6 offset0:0 offset1:8
    ds_read2_b32 v[46:47], v6 offset0:128 offset1:136
    v_add_u32 v6, 1024, v6
    ds_read2_b32 v[48:49], v6 offset0:0 offset1:8
    ds_read2_b32 v[50:51], v6 offset0:128 offset1:136
    v_add_u32 v6, 1024, v6
    ds_read2_b32 v[52:53], v6 offset0:0 offset1:8
    ds_read2_b32 v[54:55], v6 offset0:128 offset1:136
    v_add_u32 v6, 1024, v6
    ds_read2_b32 v[56:57], v6 offset0:0 offset1:8
    ds_read2_b32 v[58:59], v6 offset0:128 offset1:136
    v_add_u32 v6, 1024, v6
    ds_read2_b32 v[60:61], v6 offset0:0 offset1:8
    ds_read2_b32 v[62:63], v6 offset0:128 offset1:136
    v_add_u32 v6, 1024, v6
    ds_read2_b32 v[64:65], v6 offset0:0 offset1:8
    ds_read2_b32 v[66:67], v6 offset0:128 offset1:136
    v_add_u32 v6, 1024, v6
    ds_read2_b32 v[68:69], v6 offset0:0 offset1:8
    ds_read2_b32 v[70:71], v6 offset0:128 offset1:136
    s_waitcnt lgkmcnt(0)
    s_nop 0
    v_pk_add_f32 v[8:9], v[8:9], v[12:13]
    v_pk_add_f32 v[10:11], v[10:11], v[14:15]
    v_pk_add_f32 v[8:9], v[8:9], v[16:17]
    v_pk_add_f32 v[10:11], v[10:11], v[18:19]
    v_pk_add_f32 v[8:9], v[8:9], v[20:21]
    v_pk_add_f32 v[10:11], v[10:11], v[22:23]
    v_pk_add_f32 v[8:9], v[8:9], v[24:25]
    v_pk_add_f32 v[10:11], v[10:11], v[26:27]
    v_pk_add_f32 v[8:9], v[8:9], v[28:29]
    v_pk_add_f32 v[10:11], v[10:11], v[30:31]
    v_pk_add_f32 v[8:9], v[8:9], v[32:33]
    v_pk_add_f32 v[10:11], v[10:11], v[34:35]
    v_pk_add_f32 v[8:9], v[8:9], v[36:37]
    v_pk_add_f32 v[10:11], v[10:11], v[38:39]
    v_pk_add_f32 v[8:9], v[8:9], v[40:41]
    v_pk_add_f32 v[10:11], v[10:11], v[42:43]
    v_pk_add_f32 v[8:9], v[8:9], v[44:45]
    v_pk_add_f32 v[10:11], v[10:11], v[46:47]
    v_pk_add_f32 v[8:9], v[8:9], v[48:49]
    v_pk_add_f32 v[10:11], v[10:11], v[50:51]
    v_pk_add_f32 v[8:9], v[8:9], v[52:53]
    v_pk_add_f32 v[10:11], v[10:11], v[54:55]
    v_pk_add_f32 v[8:9], v[8:9], v[56:57]
    v_pk_add_f32 v[10:11], v[10:11], v[58:59]
    v_pk_add_f32 v[8:9], v[8:9], v[60:61]
    v_pk_add_f32 v[10:11], v[10:11], v[62:63]
    v_pk_add_f32 v[8:9], v[8:9], v[64:65]
    v_pk_add_f32 v[10:11], v[10:11], v[66:67]
    v_pk_add_f32 v[8:9], v[8:9], v[68:69]
    v_pk_add_f32 v[10:11], v[10:11], v[70:71]
    v_pk_add_f32 v[8:9], v[8:9], v[10:11]
    v_mul_f32 v8, 0x3b124925, v8
    v_mul_f32 v9, 0x3b124925, v9
    v_fma_f32 v9, -v8, v8, v9
    v_max_f32_e64 v9, 0, v9
    v_cvt_pk_bf16_f32 v9, v9, v9
    v_lshlrev_b32_e64 v9, 16, v9
    v_add_f32 v9, 0x3727c5ac, v9
    v_cvt_pk_bf16_f32 v9, v9, v9
    v_lshlrev_b32 v9, 16, v9
    v_sqrt_f32_e64 v9, v9
    s_nop 0
    v_cvt_pk_bf16_f32 v10, v8, v9
    v_mov_b32 v11, s55
    s_lshl_b32 s51, s53, 3
    s_add_u32 s51, s51, 24576
    v_lshl_add_u32 v6, v2, 3, s51
    buffer_store_dwordx2 v[10:11], v6, s[56:59], 0 offen sc1
L_k2_apf:
    s_barrier
    s_sub_u32 s51, s78, 28
    s_mul_i32 s51, s51, 7
    s_min_u32 s52, s48, 6
    s_add_u32 s51, s51, s52
    s_mul_i32 s51, s51, 57344
    s_add_u32 s51, s51, 2125824
    v_lshlrev_b32 v100, 7, v2
    buffer_load_dword v101, v100, s[56:59], s51 offen
    s_add_u32 s51, s51, 8192
    buffer_load_dword v102, v100, s[56:59], s51 offen
    s_add_u32 s51, s51, 8192
    buffer_load_dword v103, v100, s[56:59], s51 offen
    s_add_u32 s51, s51, 8192
    v_min_u32 v100, 3968, v100
    buffer_load_dword v104, v100, s[56:59], s51 offen
    s_add_u32 s51, s51, 8192
L_k2_kernel_exit:
    s_endpgm
all_code_end:
.section .rodata,"a"
.p2align 6
.amdhsa_kernel k1_kernel
  .amdhsa_next_free_vgpr 256
  .amdhsa_next_free_sgpr 102
  .amdhsa_accum_offset 256
  .amdhsa_group_segment_fixed_size 0
  .amdhsa_kernarg_size 128
  .amdhsa_user_sgpr_count 2
  .amdhsa_user_sgpr_kernarg_segment_ptr 1
  .amdhsa_system_sgpr_workgroup_id_x 1
.end_amdhsa_kernel
.p2align 6
.amdhsa_kernel k2_kernel
  .amdhsa_next_free_vgpr 256
  .amdhsa_next_free_sgpr 102
  .amdhsa_accum_offset 256
  .amdhsa_group_segment_fixed_size 0
  .amdhsa_kernarg_size 128
  .amdhsa_user_sgpr_count 2
  .amdhsa_user_sgpr_kernarg_segment_ptr 1
  .amdhsa_system_sgpr_workgroup_id_x 1
.end_amdhsa_kernel
```
